```python
import torch

def _softmax(x, axis=-1):
    return torch.softmax(x, dim=axis)
def _gelu(x):
    return torch.nn.functional.gelu(x, approximate="tanh")
def _silu(x):
    return torch.nn.functional.silu(x)
def _sigmoid(x):
    return torch.sigmoid(x)
def _layernorm(x, axis=-1, eps=1e-5):
    m = x.mean(dim=axis, keepdim=True)
    v = x.var(dim=axis, keepdim=True, unbiased=False)
    return (x - m) / torch.sqrt(v + eps)
def _scatter_add(tgt, idx, src, axis=0):
    return tgt.clone().index_add_(axis, idx, src)
def _segment_sum(src, seg, n):
    out = torch.zeros((n,) + src.shape[1:], dtype=src.dtype)
    return out.index_add_(0, seg, src)
def _pad(x, pw):
    flat = tuple(v for pair in reversed(pw) for v in pair)
    return torch.nn.functional.pad(x, flat)

kernel_name = 'gated_mix__softmax_full_mha__ssm_conv_h3__prompt'

def setup_inputs():

    _w = (lambda a: (lambda t: t.to(torch.bfloat16) if t.is_floating_point() else t)(torch.as_tensor(a)))
    def _A_setup():
        B, S, D = 1, 2048, 640
        return {
            "x": _w((lambda *s: torch.randn(*s, dtype=torch.bfloat16) * 0.05)(B, S, D)),
            "wqkv": _w((lambda *s: torch.randn(*s, dtype=torch.bfloat16) * 0.8)(D, 3 * D)),
            "wo": _w((lambda *s: torch.randn(*s, dtype=torch.bfloat16) * 0.05)(D, D)),
        }
    _A_in = _A_setup()

    def _B_setup():
        B, S, D = 1, 2048, 640
        ks = 4
        return {
            "q": _w((lambda *s: torch.randn(*s, dtype=torch.bfloat16) * 0.05)(B, S, D)),
            "k": _w((lambda *s: torch.randn(*s, dtype=torch.bfloat16) * 0.8)(B, S, D)),
            "v": _w((lambda *s: torch.randn(*s, dtype=torch.bfloat16) * 0.4)(B, S, D)),
            "shift_k": _w((lambda *s: torch.randn(*s, dtype=torch.bfloat16) * 0.8)(D, ks) * 0.5),
            "ssm_k": _w((lambda *s: torch.randn(*s, dtype=torch.bfloat16) * 0.8)(D, S) * (1.0 / S ** 0.5)),
            "ssm_D": _w((lambda *s: torch.randn(*s, dtype=torch.bfloat16) * 0.4)(D)),
        }
    _B_in = _B_setup()

    return {
        "A_x": _A_in["x"],
        "A_wqkv": _A_in["wqkv"],
        "A_wo": _A_in["wo"],
        "B_q": _B_in["q"],
        "B_k": _B_in["k"],
        "B_v": _B_in["v"],
        "B_shift_k": _B_in["shift_k"],
        "B_ssm_k": _B_in["ssm_k"],
        "B_ssm_D": _B_in["ssm_D"],
        "gate_w": _w((lambda *s: torch.randn(*s, dtype=torch.bfloat16) * 0.05)(640) * 16.0),
    }

def reference(A_x, A_wqkv, A_wo, B_q, B_k, B_v, B_shift_k, B_ssm_k, B_ssm_D, gate_w):
    def _A_ref(x, wqkv, wo):
        B, S, D = x.shape
        H = 32; Dh = D // H
        qkv = (lambda x, *d: x.permute(*d))((x @ wqkv).reshape(B, S, 3, H, Dh), 2, 0, 3, 1, 4)
        q, k, v = qkv[0], qkv[1], qkv[2]
        scale = Dh ** -0.5
        scores = torch.einsum("bhqd,bhkd->bhqk", q, k) * scale
        p = _softmax(scores, axis=-1)
        o = torch.einsum("bhqk,bhkd->bhqd", p, v)
        return (lambda x, *d: x.permute(*d))(o, 0, 2, 1, 3).reshape(B, S, D) @ wo

    def _B_ref(q, k, v, shift_k, ssm_k, ssm_D):
        B, S, D = q.shape
        ks = shift_k.shape[-1]
        k_pad = _pad(k, ((0, 0), (ks - 1, 0), (0, 0)))
        k_shift = torch.zeros_like(k)
        for t in range(ks):
            k_shift = k_shift + k_pad[:, t:t + S, :] * shift_k[:, ks - 1 - t][None, None, :]
        kv = k_shift * v
        L = 2 * S
        kv_pad = _pad(kv, ((0, 0), (0, S), (0, 0)))
        kf_pad = _pad(ssm_k, ((0, 0), (0, S)))
        kv_f = (lambda x, axes=(-2,-1): torch.fft.rfft2(x.float(), dim=axes))(kv_pad[:, None, :, :], axes=(1, 2))
        kf_f = (lambda x, axes=(-2,-1): torch.fft.rfft2(x.float(), dim=axes))(kf_pad[:, None, :], axes=(1, 2))
        kf_f = (lambda x, *d: x.permute(*d))(kf_f, 1, 2, 0)
        y_f = kv_f * kf_f[None, :, :, :]
        y = (lambda x, s, axes=(-2,-1): torch.fft.irfft2(x, s=s, dim=axes).to(torch.bfloat16))(y_f, (1, L), axes=(1, 2))[:, 0, :S, :]
        y = y + kv * ssm_D[None, None, :]
        return q * y

    x = A_x
    g = _sigmoid((x * gate_w).sum(-1, keepdims=True))
    a = _A_ref(x, A_wqkv, A_wo)
    b = _B_ref(x, B_k, B_v, B_shift_k, B_ssm_k, B_ssm_D)
    return g * a + (1 - g) * b
```

```asm
; @launch grid=(256,1,1) block=(768,1,1) lds=163840
.amdgcn_target "amdgcn-amd-amdhsa--gfx950"
.text
.globl gated_mix__softmax_full_mha__ssm_conv_h3__prompt_kernel
.p2align 8
.type gated_mix__softmax_full_mha__ssm_conv_h3__prompt_kernel,@function
gated_mix__softmax_full_mha__ssm_conv_h3__prompt_kernel:
    s_cmp_ge_u32 s2, 256
    s_cbranch_scc1 L_END
    s_load_dwordx4 s[4:7], s[0:1], 0
    s_load_dwordx2 s[8:9], s[0:1], 96
    s_load_dwordx2 s[60:61], s[0:1], 16
    s_load_dwordx8 s[64:71], s[0:1], 32
    s_load_dwordx4 s[72:75], s[0:1], 64
    s_load_dwordx4 s[76:79], s[0:1], 80
    v_and_b32 v1, 63, v0
    v_lshrrev_b32 v2, 6, v0
    s_nop 0
    v_readfirstlane_b32 s26, v2
    s_mov_b32 s56, 0
    s_mov_b32 s57, 0
    v_mov_b32 v151, 0
    s_waitcnt lgkmcnt(0)
    s_mov_b32 s12, s8
    s_and_b32 s13, s9, 0xffff
    s_mov_b32 s14, 0x1400000
    s_mov_b32 s15, 0x00020000
    s_cmp_lg_u32 s2, 0
    s_cbranch_scc1 L_NOPUB
    s_cmp_lg_u32 s26, 8
    s_cbranch_scc1 L_NOPUB
    s_memrealtime s[56:57]
    s_mov_b32 s16, s78
    s_and_b32 s17, s79, 0xffff
    s_mov_b32 s18, 0x100
    s_mov_b32 s19, 0x00020000
    s_waitcnt lgkmcnt(0)
    s_or_b32 s56, s56, 1
    s_not_b32 s57, s56
    v_mov_b32 v2, 0
    v_mov_b32 v4, s56
    v_mov_b32 v5, s57
    s_mov_b64 exec, 1
    buffer_store_dwordx2 v[4:5], v2, s[16:19], 0 offen sc0 sc1
    s_mov_b64 exec, -1
L_NOPUB:
    v_lshlrev_b32 v2, 2, v1
    v_add_u32 v2, 163592, v2
    v_mov_b32 v4, 0
    s_mov_b32 exec_hi, 0
    ds_write_b32 v2, v4
    s_mov_b64 exec, -1
    s_cmp_ge_u32 s2, 192
    s_cbranch_scc1 P1_E
    s_and_b32 s3, s2, 7
    s_lshr_b32 s10, s2, 3
    s_and_b32 s24, s3, 3
    s_lshl_b32 s24, s24, 2
    s_and_b32 s11, s10, 3
    s_add_u32 s24, s24, s11
    s_lshr_b32 s25, s3, 2
    s_mul_i32 s25, s25, 6
    s_lshr_b32 s10, s10, 2
    s_add_u32 s25, s25, s10
    s_lshl_b32 s27, s24, 7
    s_lshr_b32 s28, s25, 2
    s_and_b32 s29, s25, 3
    s_lshl_b32 s29, s29, 3
    s_lshl_b32 s55, s25, 4
    s_add_u32 s55, s55, s24
    s_cmp_lt_u32 s26, 8
    s_cbranch_scc1 P1_COMP
    s_mov_b32 s16, s4
    s_and_b32 s17, s5, 0xffff
    s_mov_b32 s18, 0x280000
    s_mov_b32 s19, 0x00020000
    s_mov_b32 s20, s6
    s_and_b32 s21, s7, 0xffff
    s_mov_b32 s22, 0x258000
    s_mov_b32 s23, 0x00020000
    s_mul_i32 s34, s11, 3
    s_mul_i32 s10, s10, 2
    s_add_u32 s34, s34, s10
    s_cmp_ge_u32 s34, 10
    s_cselect_b32 s10, 10, 0
    s_sub_u32 s34, s34, s10
    s_sub_u32 s35, s26, 8
    v_lshrrev_b32 v2, 3, v1
    v_and_b32 v3, 7, v1
    v_lshrrev_b32 v13, 4, v1
    s_lshl_b32 s10, s35, 5
    s_add_u32 s10, s10, s27
    v_add_u32 v2, s10, v2
    s_movk_i32 s11, 1280
    v_mul_lo_u32 v2, v2, s11
    v_xor_b32 v14, v3, v13
    v_xor_b32 v15, 4, v14
    v_lshlrev_b32 v14, 4, v14
    v_lshlrev_b32 v15, 4, v15
    v_add_u32 v4, 0, v2
    v_add_u32 v4, v4, v14
    v_add_u32 v5, 9216, v2
    v_add_u32 v5, v5, v15
    v_add_u32 v6, 18432, v2
    v_add_u32 v6, v6, v14
    v_add_u32 v7, 27648, v2
    v_add_u32 v7, v7, v15
    s_mul_i32 s10, s25, 320
    s_mul_i32 s11, s35, 61440
    s_add_u32 s10, s10, s11
    s_movk_i32 s11, 3840
    v_add_u32 v2, 0, v1
    v_mul_u32_u24 v3, 0xcccd, v2
    v_lshrrev_b32 v3, 20, v3
    v_mul_u32_u24 v14, 20, v3
    v_sub_u32 v2, v2, v14
    v_lshrrev_b32 v14, 3, v3
    v_and_b32 v14, 1, v14
    v_lshlrev_b32 v14, 1, v14
    v_xor_b32 v2, v2, v14
    v_lshlrev_b32 v2, 4, v2
    v_mul_lo_u32 v3, v3, s11
    v_add3_u32 v2, v2, v3, s10
    v_mov_b32 v8, v2
    v_add_u32 v2, 64, v1
    v_mul_u32_u24 v3, 0xcccd, v2
    v_lshrrev_b32 v3, 20, v3
    v_mul_u32_u24 v14, 20, v3
    v_sub_u32 v2, v2, v14
    v_lshrrev_b32 v14, 3, v3
    v_and_b32 v14, 1, v14
    v_lshlrev_b32 v14, 1, v14
    v_xor_b32 v2, v2, v14
    v_lshlrev_b32 v2, 4, v2
    v_mul_lo_u32 v3, v3, s11
    v_add3_u32 v2, v2, v3, s10
    v_subrev_u32 v9, 1024, v2
    v_add_u32 v2, 128, v1
    v_mul_u32_u24 v3, 0xcccd, v2
    v_lshrrev_b32 v3, 20, v3
    v_mul_u32_u24 v14, 20, v3
    v_sub_u32 v2, v2, v14
    v_lshrrev_b32 v14, 3, v3
    v_and_b32 v14, 1, v14
    v_lshlrev_b32 v14, 1, v14
    v_xor_b32 v2, v2, v14
    v_lshlrev_b32 v2, 4, v2
    v_mul_lo_u32 v3, v3, s11
    v_add3_u32 v2, v2, v3, s10
    v_subrev_u32 v10, 2048, v2
    v_add_u32 v2, 192, v1
    v_mul_u32_u24 v3, 0xcccd, v2
    v_lshrrev_b32 v3, 20, v3
    v_mul_u32_u24 v14, 20, v3
    v_sub_u32 v2, v2, v14
    v_lshrrev_b32 v14, 3, v3
    v_and_b32 v14, 1, v14
    v_lshlrev_b32 v14, 1, v14
    v_xor_b32 v2, v2, v14
    v_lshlrev_b32 v2, 4, v2
    v_mul_lo_u32 v3, v3, s11
    v_add3_u32 v2, v2, v3, s10
    v_subrev_u32 v11, 3072, v2
    v_add_u32 v2, 256, v1
    v_mul_u32_u24 v3, 0xcccd, v2
    v_lshrrev_b32 v3, 20, v3
    v_mul_u32_u24 v14, 20, v3
    v_sub_u32 v2, v2, v14
    v_lshrrev_b32 v14, 3, v3
    v_and_b32 v14, 1, v14
    v_lshlrev_b32 v14, 1, v14
    v_xor_b32 v2, v2, v14
    v_lshlrev_b32 v2, 4, v2
    v_mul_lo_u32 v3, v3, s11
    v_add3_u32 v2, v2, v3, s10
    v_mov_b32 v12, v2
    s_lshl_b32 s42, s35, 12
    s_mul_i32 s43, s35, 5120
    s_add_u32 s43, s43, 16384
    s_mov_b32 s32, 0
    s_mov_b32 s33, 0
    s_mov_b32 s36, s78
    s_and_b32 s37, s79, 0xffff
    s_mov_b32 s38, 0x100
    s_mov_b32 s39, 0x00020000
    v_mov_b32 v16, 0
    v_lshlrev_b32 v20, 6, v1
    v_add_u32 v20, 0x1213000, v20
    s_lshl_b32 s30, s34, 7
    s_mul_i32 s31, s34, 245760
    s_add_u32 m0, s32, s42
    s_add_u32 s34, s34, 1
    buffer_load_dwordx4 v4, s[16:19], s30 offen lds
    buffer_load_dwordx4 v5, s[16:19], s30 offen offset:1024 lds
    buffer_load_dwordx4 v6, s[16:19], s30 offen offset:2048 lds
    buffer_load_dwordx4 v7, s[16:19], s30 offen offset:3072 lds
    s_add_u32 m0, s32, s43
    s_cmp_ge_u32 s34, 10
    buffer_load_dwordx4 v8, s[20:23], s31 offen lds
    buffer_load_dwordx4 v9, s[20:23], s31 offen offset:1024 lds
    buffer_load_dwordx4 v10, s[20:23], s31 offen offset:2048 lds
    buffer_load_dwordx4 v11, s[20:23], s31 offen offset:3072 lds
    s_cselect_b32 s34, 0, s34
    s_add_u32 m0, m0, 4096
    s_add_u32 s32, s32, 36864
    buffer_load_dwordx4 v12, s[20:23], s31 offen lds
    s_cmp_ge_u32 s32, 147456
    s_cselect_b32 s32, 0, s32
    s_lshl_b32 s30, s34, 7
    s_mul_i32 s31, s34, 245760
    s_add_u32 m0, s32, s42
    s_add_u32 s34, s34, 1
    buffer_load_dwordx4 v4, s[16:19], s30 offen lds
    buffer_load_dwordx4 v5, s[16:19], s30 offen offset:1024 lds
    buffer_load_dwordx4 v6, s[16:19], s30 offen offset:2048 lds
    buffer_load_dwordx4 v7, s[16:19], s30 offen offset:3072 lds
    s_add_u32 m0, s32, s43
    s_cmp_ge_u32 s34, 10
    buffer_load_dwordx4 v8, s[20:23], s31 offen lds
    buffer_load_dwordx4 v9, s[20:23], s31 offen offset:1024 lds
    buffer_load_dwordx4 v10, s[20:23], s31 offen offset:2048 lds
    buffer_load_dwordx4 v11, s[20:23], s31 offen offset:3072 lds
    s_cselect_b32 s34, 0, s34
    s_add_u32 m0, m0, 4096
    s_add_u32 s32, s32, 36864
    buffer_load_dwordx4 v12, s[20:23], s31 offen lds
    s_cmp_ge_u32 s32, 147456
    s_cselect_b32 s32, 0, s32
    s_waitcnt vmcnt(9) lgkmcnt(0)
    s_barrier
    s_lshl_b32 s30, s34, 7
    s_mul_i32 s31, s34, 245760
    s_add_u32 m0, s32, s42
    s_add_u32 s34, s34, 1
    buffer_load_dwordx4 v4, s[16:19], s30 offen lds
    buffer_load_dwordx4 v5, s[16:19], s30 offen offset:1024 lds
    buffer_load_dwordx4 v6, s[16:19], s30 offen offset:2048 lds
    buffer_load_dwordx4 v7, s[16:19], s30 offen offset:3072 lds
    s_add_u32 m0, s32, s43
    s_cmp_ge_u32 s34, 10
    buffer_load_dwordx4 v8, s[20:23], s31 offen lds
    buffer_load_dwordx4 v9, s[20:23], s31 offen offset:1024 lds
    buffer_load_dwordx4 v10, s[20:23], s31 offen offset:2048 lds
    buffer_load_dwordx4 v11, s[20:23], s31 offen offset:3072 lds
    s_cselect_b32 s34, 0, s34
    s_add_u32 m0, m0, 4096
    s_add_u32 s32, s32, 36864
    buffer_load_dwordx4 v12, s[20:23], s31 offen lds
    s_cmp_ge_u32 s32, 147456
    s_cselect_b32 s32, 0, s32
    s_lshl_b32 s30, s34, 7
    s_mul_i32 s31, s34, 245760
    s_add_u32 m0, s32, s42
    s_add_u32 s34, s34, 1
    buffer_load_dwordx4 v4, s[16:19], s30 offen lds
    buffer_load_dwordx4 v5, s[16:19], s30 offen offset:1024 lds
    buffer_load_dwordx4 v6, s[16:19], s30 offen offset:2048 lds
    buffer_load_dwordx4 v7, s[16:19], s30 offen offset:3072 lds
    s_add_u32 m0, s32, s43
    s_cmp_ge_u32 s34, 10
    buffer_load_dwordx4 v8, s[20:23], s31 offen lds
    buffer_load_dwordx4 v9, s[20:23], s31 offen offset:1024 lds
    buffer_load_dwordx4 v10, s[20:23], s31 offen offset:2048 lds
    buffer_load_dwordx4 v11, s[20:23], s31 offen offset:3072 lds
    s_cselect_b32 s34, 0, s34
    s_add_u32 m0, m0, 4096
    s_add_u32 s32, s32, 36864
    buffer_load_dwordx4 v12, s[20:23], s31 offen lds
    s_cmp_ge_u32 s32, 147456
    s_cselect_b32 s32, 0, s32
    buffer_load_dwordx2 v[18:19], v16, s[36:39], 0 offen sc0 sc1
    s_mov_b32 s33, 4
P1_LLOOP:
    s_waitcnt vmcnt(18)
    s_barrier
    s_lshl_b32 s30, s34, 7
    s_mul_i32 s31, s34, 245760
    s_add_u32 m0, s32, s42
    s_add_u32 s34, s34, 1
    buffer_load_dwordx4 v4, s[16:19], s30 offen lds
    buffer_load_dwordx4 v5, s[16:19], s30 offen offset:1024 lds
    buffer_load_dwordx4 v6, s[16:19], s30 offen offset:2048 lds
    buffer_load_dwordx4 v7, s[16:19], s30 offen offset:3072 lds
    s_add_u32 m0, s32, s43
    s_cmp_ge_u32 s34, 10
    buffer_load_dwordx4 v8, s[20:23], s31 offen lds
    buffer_load_dwordx4 v9, s[20:23], s31 offen offset:1024 lds
    buffer_load_dwordx4 v10, s[20:23], s31 offen offset:2048 lds
    buffer_load_dwordx4 v11, s[20:23], s31 offen offset:3072 lds
    s_cselect_b32 s34, 0, s34
    s_add_u32 m0, m0, 4096
    s_add_u32 s32, s32, 36864
    buffer_load_dwordx4 v12, s[20:23], s31 offen lds
    s_cmp_ge_u32 s32, 147456
    s_cselect_b32 s32, 0, s32
    s_add_u32 s33, s33, 1
    s_cmp_lt_u32 s33, 10
    s_cbranch_scc1 P1_LLOOP
    s_waitcnt vmcnt(18)
    s_barrier
    s_mov_b32 s58, 0
    s_branch NONC_2
NON_1:
    buffer_load_dwordx2 v[18:19], v16, s[36:39], 0 offen sc0 sc1
    s_waitcnt vmcnt(0)
NONC_2:
    v_readfirstlane_b32 s56, v18
    v_readfirstlane_b32 s57, v19
    s_add_u32 s58, s58, 1
    s_cmp_gt_u32 s58, 30000
    s_cbranch_scc1 NOND_3
    s_not_b32 s59, s56
    s_cmp_lg_u32 s59, s57
    s_cbranch_scc1 NON_1
NOND_3:
    s_cmp_lg_u32 s26, 8
    s_cbranch_scc1 P1_LNON
    v_mov_b32 v16, 163584
    v_mov_b32 v18, s56
    v_mov_b32 v19, s57
    ds_write_b64 v16, v[18:19]
    s_waitcnt lgkmcnt(0)
P1_LNON:
    s_mov_b32 s18, 40960
    v_add_u32 v24, 0, v1
    v_mul_u32_u24 v25, 0xcccd, v24
    v_lshrrev_b32 v25, 18, v25
    v_mul_u32_u24 v26, 5, v25
    v_sub_u32 v24, v24, v26
    v_min_u32 v24, 3, v24
    v_mul_lo_u32 v25, v25, s18
    v_lshl_add_u32 v28, v24, 4, v25
    v_add_u32 v24, 64, v1
    v_mul_u32_u24 v25, 0xcccd, v24
    v_lshrrev_b32 v25, 18, v25
    v_mul_u32_u24 v26, 5, v25
    v_sub_u32 v24, v24, v26
    v_min_u32 v24, 3, v24
    v_mul_lo_u32 v25, v25, s18
    v_lshl_add_u32 v29, v24, 4, v25
    v_add_u32 v24, 128, v1
    v_mul_u32_u24 v25, 0xcccd, v24
    v_lshrrev_b32 v25, 18, v25
    v_mul_u32_u24 v26, 5, v25
    v_sub_u32 v24, v24, v26
    v_min_u32 v24, 3, v24
    v_mul_lo_u32 v25, v25, s18
    v_lshl_add_u32 v30, v24, 4, v25
    v_add_u32 v24, 192, v1
    v_mul_u32_u24 v25, 0xcccd, v24
    v_lshrrev_b32 v25, 18, v25
    v_mul_u32_u24 v26, 5, v25
    v_sub_u32 v24, v24, v26
    v_min_u32 v24, 3, v24
    v_mul_lo_u32 v25, v25, s18
    v_lshl_add_u32 v31, v24, 4, v25
    v_add_u32 v24, 256, v1
    v_mul_u32_u24 v25, 0xcccd, v24
    v_lshrrev_b32 v25, 18, v25
    v_mul_u32_u24 v26, 5, v25
    v_sub_u32 v24, v24, v26
    v_min_u32 v24, 3, v24
    v_mul_lo_u32 v25, v25, s18
    v_lshl_add_u32 v32, v24, 4, v25
    v_mov_b32 v24, 163652
    v_mov_b32 v25, 1
    s_waitcnt vmcnt(9)
    s_barrier
    s_waitcnt vmcnt(0)
    s_cmp_lg_u32 s26, 9
    s_cbranch_scc1 EI_4
    buffer_load_dwordx2 v[22:23], v20, s[12:15], 0 offen sc0 sc1
EI_4:
    s_barrier
    s_barrier
    s_waitcnt vmcnt(0)
    s_cmp_lg_u32 s26, 9
    s_cbranch_scc1 EC_5
    v_cmp_ne_u64 vcc, s[56:57], v[22:23]
    s_cmp_lg_u64 vcc, 0
    s_cbranch_scc1 EC_5
    ds_write_b32 v24, v25
    s_waitcnt lgkmcnt(0)
EC_5:
    s_cmp_lg_u32 s26, 9
    s_cbranch_scc1 EI_6
    buffer_load_dwordx2 v[22:23], v20, s[12:15], 0 offen sc0 sc1
EI_6:
    s_barrier
    ds_read_b32 v26, v24
    s_sub_u32 s35, s26, 8
    s_lshl_b32 s17, s35, 2
    s_or_b32 s17, s17, 0x40000
    s_and_b32 s18, s2, 1
    s_mov_b32 s51, 0x20002111
    s_cmp_eq_u32 s18, 0
    s_cselect_b32 s51, s51, 0x2002211
    s_bfe_u32 s51, s51, s17
    s_mov_b32 s50, 0x10000210
    s_cmp_eq_u32 s18, 0
    s_cselect_b32 s50, s50, 0x3004243
    s_bfe_u32 s50, s50, s17
    s_mov_b32 s16, 0x30003210
    s_cmp_eq_u32 s18, 0
    s_cselect_b32 s16, s16, 0x2002210
    s_bfe_u32 s16, s16, s17
    s_mov_b32 s19, 0x10000000
    s_cmp_eq_u32 s18, 0
    s_cselect_b32 s19, s19, 0x1002000
    s_bfe_u32 s19, s19, s17
    s_lshr_b32 s18, s2, 1
    s_mul_i32 s18, s18, 5
    s_add_u32 s50, s50, s18
    s_mul_i32 s16, s16, 24240
    s_mul_i32 s19, s19, 13488
    s_add_u32 s16, s16, s19
    s_add_u32 s16, s16, 51200
    s_waitcnt lgkmcnt(0)
    v_readfirstlane_b32 s10, v26
    s_cmp_eq_u32 s10, 0
    s_cbranch_scc0 P1_UF
    v_mov_b32 v4, 163652
    s_cmp_lg_u32 s26, 9
    s_cbranch_scc1 SP_7
    s_mov_b32 s10, 0
    s_branch POLLC_11
POLL_9:
    buffer_load_dwordx2 v[22:23], v20, s[12:15], 0 offen sc0 sc1
POLLC_11:
    s_waitcnt vmcnt(0)
    v_cmp_ne_u64 vcc, s[56:57], v[22:23]
    s_add_u32 s10, s10, 1
    s_cmp_gt_u32 s10, 30000
    s_cbranch_scc1 POLLD_10
    s_cmp_lg_u64 vcc, 0
    s_cbranch_scc1 POLL_9
POLLD_10:
    v_mov_b32 v5, 1
    ds_write_b32 v4, v5
    s_branch SPD_8
SP_7:
    s_mov_b32 s10, 0
LW_12:
    ds_read_b32 v5, v4
    s_waitcnt lgkmcnt(0)
    v_readfirstlane_b32 s11, v5
    s_add_u32 s10, s10, 1
    s_cmp_gt_u32 s10, 240000
    s_cbranch_scc1 LWD_13
    s_cmp_lt_u32 s11, 1
    s_cbranch_scc1 LW_12
LWD_13:
SPD_8:
P1_UF:
    s_mov_b32 s33, 1
    s_branch P1_HU2
P1_LATE:
    s_barrier
P1_HU:
    s_mov_b32 s33, 0
    v_mov_b32 v4, 163652
    s_cmp_lg_u32 s26, 9
    s_cbranch_scc1 SP_14
    s_mov_b32 s10, 0
    s_branch POLLC_18
POLL_16:
    buffer_load_dwordx2 v[22:23], v20, s[12:15], 0 offen sc0 sc1
POLLC_18:
    s_waitcnt vmcnt(0)
    v_cmp_ne_u64 vcc, s[56:57], v[22:23]
    s_add_u32 s10, s10, 1
    s_cmp_gt_u32 s10, 30000
    s_cbranch_scc1 POLLD_17
    s_cmp_lg_u64 vcc, 0
    s_cbranch_scc1 POLL_16
POLLD_17:
    v_mov_b32 v5, 1
    ds_write_b32 v4, v5
    s_branch SPD_15
SP_14:
    s_mov_b32 s10, 0
LW_19:
    ds_read_b32 v5, v4
    s_waitcnt lgkmcnt(0)
    v_readfirstlane_b32 s11, v5
    s_add_u32 s10, s10, 1
    s_cmp_gt_u32 s10, 240000
    s_cbranch_scc1 LWD_20
    s_cmp_lt_u32 s11, 1
    s_cbranch_scc1 LW_19
LWD_20:
SPD_15:
P1_HU2:
    s_lshl_b32 s17, s50, 6
    s_add_u32 s17, s17, 0x900000
    s_cmp_eq_u32 s51, 2
    s_cselect_b32 s18, 1310720, 0
    s_cselect_b32 s19, 0, -1
    s_add_u32 s17, s17, s18
    s_add_u32 m0, s16, 0
    s_nop 0
    buffer_load_dwordx4 v28, s[12:15], s17 offen sc1 lds
    s_add_u32 m0, s16, 1024
    s_nop 0
    buffer_load_dwordx4 v29, s[12:15], s17 offen sc1 lds
    s_add_u32 m0, s16, 2048
    s_mov_b32 exec_hi, s19
    buffer_load_dwordx4 v30, s[12:15], s17 offen sc1 lds
    s_mov_b32 exec_hi, -1
    s_cmp_eq_u32 s51, 2
    s_cbranch_scc1 UD_21
    s_add_u32 m0, s16, 3072
    s_nop 0
    buffer_load_dwordx4 v31, s[12:15], s17 offen sc1 lds
    s_add_u32 m0, s16, 4096
    s_nop 0
    buffer_load_dwordx4 v32, s[12:15], s17 offen sc1 lds
UD_21:
    s_add_u32 s35, s35, 4
    s_lshl_b32 s17, s35, 2
    s_or_b32 s17, s17, 0x40000
    s_and_b32 s18, s2, 1
    s_mov_b32 s51, 0x20002111
    s_cmp_eq_u32 s18, 0
    s_cselect_b32 s51, s51, 0x2002211
    s_bfe_u32 s51, s51, s17
    s_mov_b32 s50, 0x10000210
    s_cmp_eq_u32 s18, 0
    s_cselect_b32 s50, s50, 0x3004243
    s_bfe_u32 s50, s50, s17
    s_mov_b32 s16, 0x30003210
    s_cmp_eq_u32 s18, 0
    s_cselect_b32 s16, s16, 0x2002210
    s_bfe_u32 s16, s16, s17
    s_mov_b32 s19, 0x10000000
    s_cmp_eq_u32 s18, 0
    s_cselect_b32 s19, s19, 0x1002000
    s_bfe_u32 s19, s19, s17
    s_lshr_b32 s18, s2, 1
    s_mul_i32 s18, s18, 5
    s_add_u32 s50, s50, s18
    s_mul_i32 s16, s16, 24240
    s_mul_i32 s19, s19, 13488
    s_add_u32 s16, s16, s19
    s_add_u32 s16, s16, 51200
    s_cmp_eq_u32 s51, 0
    s_cbranch_scc1 P1_HU1
    s_lshl_b32 s17, s50, 6
    s_add_u32 s17, s17, 0x900000
    s_cmp_eq_u32 s51, 2
    s_cselect_b32 s18, 1310720, 0
    s_cselect_b32 s19, 0, -1
    s_add_u32 s17, s17, s18
    s_add_u32 m0, s16, 0
    s_nop 0
    buffer_load_dwordx4 v28, s[12:15], s17 offen sc1 lds
    s_add_u32 m0, s16, 1024
    s_nop 0
    buffer_load_dwordx4 v29, s[12:15], s17 offen sc1 lds
    s_add_u32 m0, s16, 2048
    s_mov_b32 exec_hi, s19
    buffer_load_dwordx4 v30, s[12:15], s17 offen sc1 lds
    s_mov_b32 exec_hi, -1
    s_cmp_eq_u32 s51, 2
    s_cbranch_scc1 UD_22
    s_add_u32 m0, s16, 3072
    s_nop 0
    buffer_load_dwordx4 v31, s[12:15], s17 offen sc1 lds
    s_add_u32 m0, s16, 4096
    s_nop 0
    buffer_load_dwordx4 v32, s[12:15], s17 offen sc1 lds
UD_22:
P1_HU1:
    s_cmp_eq_u32 s33, 0
    s_cbranch_scc1 P1_HU3
    s_barrier
P1_HU3:
    s_lshl_b32 s17, s35, 2
    s_add_u32 s17, s17, 163600
    v_mov_b32 v4, s17
    v_mov_b32 v5, 1
    s_waitcnt vmcnt(0)
    ds_write2_b32 v4, v5, v5 offset1:4
    s_branch P2_COMMON
P1_COMP:
    v_lshrrev_b32 v13, 4, v1
    s_and_b32 s10, s26, 3
    s_lshr_b32 s11, s26, 2
    v_and_b32 v2, 15, v1
    v_lshrrev_b32 v3, 1, v2
    v_xor_b32 v3, v3, v13
    s_lshl_b32 s35, s10, 5
    v_add_u32 v14, s35, v2
    v_lshlrev_b32 v14, 7, v14
    v_lshl_add_u32 v16, v3, 4, v14
    v_xor_b32 v3, 4, v3
    v_lshl_add_u32 v17, v3, 4, v14
    v_lshrrev_b32 v3, 2, v2
    v_lshl_add_u32 v3, v13, 3, v3
    v_mul_u32_u24 v3, 320, v3
    v_and_b32 v14, 3, v1
    v_lshl_add_u32 v3, v14, 3, v3
    s_mul_i32 s35, s11, 160
    s_add_u32 s35, s35, 16384
    v_add_u32 v3, s35, v3
    v_and_b32 v14, 1, v13
    v_lshlrev_b32 v14, 5, v14
    v_add_u32 v15, v3, v14
    v_sub_u32 v14, v3, v14
    s_cmp_eq_u32 s11, 0
    s_cselect_b64 vcc, -1, 0
    s_nop 1
    v_cndmask_b32 v18, v14, v15, vcc
    v_cndmask_b32 v19, v15, v14, vcc
    v_mov_b32 v84, 0
    v_mov_b32 v85, 0
    v_mov_b32 v86, 0
    v_mov_b32 v87, 0
    v_mov_b32 v88, 0
    v_mov_b32 v89, 0
    v_mov_b32 v90, 0
    v_mov_b32 v91, 0
    v_mov_b32 v92, 0
    v_mov_b32 v93, 0
    v_mov_b32 v94, 0
    v_mov_b32 v95, 0
    v_mov_b32 v96, 0
    v_mov_b32 v97, 0
    v_mov_b32 v98, 0
    v_mov_b32 v99, 0
    v_mov_b32 v100, 0
    v_mov_b32 v101, 0
    v_mov_b32 v102, 0
    v_mov_b32 v103, 0
    v_mov_b32 v104, 0
    v_mov_b32 v105, 0
    v_mov_b32 v106, 0
    v_mov_b32 v107, 0
    v_mov_b32 v108, 0
    v_mov_b32 v109, 0
    v_mov_b32 v110, 0
    v_mov_b32 v111, 0
    v_mov_b32 v112, 0
    v_mov_b32 v113, 0
    v_mov_b32 v114, 0
    v_mov_b32 v115, 0
    v_mov_b32 v116, 0
    v_mov_b32 v117, 0
    v_mov_b32 v118, 0
    v_mov_b32 v119, 0
    v_mov_b32 v120, 0
    v_mov_b32 v121, 0
    v_mov_b32 v122, 0
    v_mov_b32 v123, 0
    s_mov_b32 s33, 0
    s_mov_b32 s34, 0
    v_add_u32 v20, s33, v16
    v_add_u32 v21, s33, v17
    v_add_u32 v22, s33, v18
    v_add_u32 v23, s33, v19
    s_lshl_b32 s17, s26, 2
    s_or_b32 s17, s17, 0x40000
    s_and_b32 s18, s2, 1
    s_mov_b32 s51, 0x20002111
    s_cmp_eq_u32 s18, 0
    s_cselect_b32 s51, s51, 0x2002211
    s_bfe_u32 s51, s51, s17
    s_mov_b32 s50, 0x10000210
    s_cmp_eq_u32 s18, 0
    s_cselect_b32 s50, s50, 0x3004243
    s_bfe_u32 s50, s50, s17
    s_mov_b32 s16, 0x30003210
    s_cmp_eq_u32 s18, 0
    s_cselect_b32 s16, s16, 0x2002210
    s_bfe_u32 s16, s16, s17
    s_mov_b32 s19, 0x10000000
    s_cmp_eq_u32 s18, 0
    s_cselect_b32 s19, s19, 0x1002000
    s_bfe_u32 s19, s19, s17
    s_lshr_b32 s18, s2, 1
    s_mul_i32 s18, s18, 5
    s_add_u32 s50, s50, s18
    s_mul_i32 s16, s16, 24240
    s_mul_i32 s19, s19, 13488
    s_add_u32 s16, s16, s19
    s_add_u32 s16, s16, 51200
    s_waitcnt lgkmcnt(0)
    s_barrier
    ds_read_b128 v[28:31], v20 offset:0
    ds_read_b64_tr_b16 v[36:37], v22 offset:0
    ds_read_b64_tr_b16 v[38:39], v22 offset:1280
    ds_read_b128 v[32:35], v20 offset:2048
    ds_read_b64_tr_b16 v[40:41], v23 offset:32
    ds_read_b64_tr_b16 v[42:43], v23 offset:1312
    ds_read_b64_tr_b16 v[44:45], v22 offset:64
    ds_read_b64_tr_b16 v[46:47], v22 offset:1344
    ds_read_b64_tr_b16 v[48:49], v23 offset:96
    ds_read_b64_tr_b16 v[50:51], v23 offset:1376
    ds_read_b64_tr_b16 v[52:53], v22 offset:128
    ds_read_b64_tr_b16 v[54:55], v22 offset:1408
    s_cmp_eq_u32 s28, 2
    s_cbranch_scc1 P1_LOOP_V
.p2align 6
P1_LOOP_QK:
    s_waitcnt lgkmcnt(0)
    v_mfma_f32_16x16x32_bf16 v[84:87], v[36:39], v[28:31], v[84:87]
    ds_read_b128 v[56:59], v21 offset:0
    ds_read_b64_tr_b16 v[64:65], v22 offset:10240
    v_mfma_f32_16x16x32_bf16 v[104:107], v[36:39], v[32:35], v[104:107]
    ds_read_b64_tr_b16 v[66:67], v22 offset:11520
    ds_read_b128 v[60:63], v21 offset:2048
    v_mfma_f32_16x16x32_bf16 v[88:91], v[40:43], v[28:31], v[88:91]
    ds_read_b64_tr_b16 v[68:69], v23 offset:10272
    v_mfma_f32_16x16x32_bf16 v[108:111], v[40:43], v[32:35], v[108:111]
    ds_read_b64_tr_b16 v[70:71], v23 offset:11552
    v_mfma_f32_16x16x32_bf16 v[92:95], v[44:47], v[28:31], v[92:95]
    ds_read_b64_tr_b16 v[72:73], v22 offset:10304
    v_mfma_f32_16x16x32_bf16 v[112:115], v[44:47], v[32:35], v[112:115]
    ds_read_b64_tr_b16 v[74:75], v22 offset:11584
    v_mfma_f32_16x16x32_bf16 v[96:99], v[48:51], v[28:31], v[96:99]
    ds_read_b64_tr_b16 v[76:77], v23 offset:10336
    v_mfma_f32_16x16x32_bf16 v[116:119], v[48:51], v[32:35], v[116:119]
    ds_read_b64_tr_b16 v[78:79], v23 offset:11616
    v_mfma_f32_16x16x32_bf16 v[100:103], v[52:55], v[28:31], v[100:103]
    ds_read_b64_tr_b16 v[80:81], v22 offset:10368
    v_mfma_f32_16x16x32_bf16 v[120:123], v[52:55], v[32:35], v[120:123]
    ds_read_b64_tr_b16 v[82:83], v22 offset:11648
    s_add_u32 s33, s33, 36864
    s_cmp_ge_u32 s33, 147456
    s_cselect_b32 s33, 0, s33
    s_waitcnt lgkmcnt(0)
    s_barrier
    v_add_u32 v20, s33, v16
    v_add_u32 v21, s33, v17
    v_add_u32 v22, s33, v18
    v_add_u32 v23, s33, v19
    s_waitcnt lgkmcnt(0)
    v_mfma_f32_16x16x32_bf16 v[84:87], v[64:67], v[56:59], v[84:87]
    ds_read_b128 v[28:31], v20 offset:0
    ds_read_b64_tr_b16 v[36:37], v22 offset:0
    v_mfma_f32_16x16x32_bf16 v[104:107], v[64:67], v[60:63], v[104:107]
    ds_read_b64_tr_b16 v[38:39], v22 offset:1280
    ds_read_b128 v[32:35], v20 offset:2048
    v_mfma_f32_16x16x32_bf16 v[88:91], v[68:71], v[56:59], v[88:91]
    ds_read_b64_tr_b16 v[40:41], v23 offset:32
    v_mfma_f32_16x16x32_bf16 v[108:111], v[68:71], v[60:63], v[108:111]
    ds_read_b64_tr_b16 v[42:43], v23 offset:1312
    v_mfma_f32_16x16x32_bf16 v[92:95], v[72:75], v[56:59], v[92:95]
    ds_read_b64_tr_b16 v[44:45], v22 offset:64
    v_mfma_f32_16x16x32_bf16 v[112:115], v[72:75], v[60:63], v[112:115]
    ds_read_b64_tr_b16 v[46:47], v22 offset:1344
    v_mfma_f32_16x16x32_bf16 v[96:99], v[76:79], v[56:59], v[96:99]
    ds_read_b64_tr_b16 v[48:49], v23 offset:96
    v_mfma_f32_16x16x32_bf16 v[116:119], v[76:79], v[60:63], v[116:119]
    ds_read_b64_tr_b16 v[50:51], v23 offset:1376
    v_mfma_f32_16x16x32_bf16 v[100:103], v[80:83], v[56:59], v[100:103]
    ds_read_b64_tr_b16 v[52:53], v22 offset:128
    v_mfma_f32_16x16x32_bf16 v[120:123], v[80:83], v[60:63], v[120:123]
    ds_read_b64_tr_b16 v[54:55], v22 offset:1408
    s_add_u32 s34, s34, 1
    s_cmp_lt_u32 s34, 10
    s_cbranch_scc1 P1_LOOP_QK
    s_waitcnt lgkmcnt(0)
    s_barrier
    s_cmp_eq_u32 s51, 0
    s_cbranch_scc1 P1_LOOP_QK_NH
    s_mov_b32 s20, s70
    s_and_b32 s21, s71, 0xffff
    s_mov_b32 s22, 0x280000
    s_mov_b32 s23, 0x00020000
    s_lshl_b32 s17, s50, 12
    v_lshlrev_b32 v148, 4, v1
    buffer_load_dwordx4 v[124:127], v148, s[20:23], s17 offen offset:0 nt
    buffer_load_dwordx4 v[128:131], v148, s[20:23], s17 offen offset:1024 nt
    buffer_load_dwordx4 v[132:135], v148, s[20:23], s17 offen offset:2048 nt
    buffer_load_dwordx4 v[136:139], v148, s[20:23], s17 offen offset:3072 nt
    buffer_load_dwordx2 v[140:141], v148, s[20:23], s17 offen offset:16 nt
    buffer_load_dwordx2 v[142:143], v148, s[20:23], s17 offen offset:1040 nt
    buffer_load_dwordx2 v[144:145], v148, s[20:23], s17 offen offset:2064 nt
    buffer_load_dwordx2 v[146:147], v148, s[20:23], s17 offen offset:3088 nt
P1_LOOP_QK_NH:
    s_mul_i32 s35, s11, 80
    s_lshl_b32 s44, s10, 5
    v_add_u32 v3, s44, v2
    v_mul_u32_u24 v3, 48, v3
    v_lshlrev_b32 v14, 2, v13
    v_add_u32 v14, s35, v14
    v_add_u32 v15, 0, v14
    v_mul_u32_u24 v24, 0xcccd, v15
    v_lshrrev_b32 v24, 20, v24
    v_mul_u32_u24 v25, 20, v24
    v_sub_u32 v25, v15, v25
    v_mul_u32_u24 v24, 6144, v24
    v_lshl_add_u32 v24, v25, 1, v24
    v_add_u32 v28, v24, v3
    v_add_u32 v15, 16, v14
    v_mul_u32_u24 v24, 0xcccd, v15
    v_lshrrev_b32 v24, 20, v24
    v_mul_u32_u24 v25, 20, v24
    v_sub_u32 v25, v15, v25
    v_mul_u32_u24 v24, 6144, v24
    v_lshl_add_u32 v24, v25, 1, v24
    v_add_u32 v29, v24, v3
    v_add_u32 v15, 32, v14
    v_mul_u32_u24 v24, 0xcccd, v15
    v_lshrrev_b32 v24, 20, v24
    v_mul_u32_u24 v25, 20, v24
    v_sub_u32 v25, v15, v25
    v_mul_u32_u24 v24, 6144, v24
    v_lshl_add_u32 v24, v25, 1, v24
    v_add_u32 v30, v24, v3
    v_add_u32 v15, 48, v14
    v_mul_u32_u24 v24, 0xcccd, v15
    v_lshrrev_b32 v24, 20, v24
    v_mul_u32_u24 v25, 20, v24
    v_sub_u32 v25, v15, v25
    v_mul_u32_u24 v24, 6144, v24
    v_lshl_add_u32 v24, v25, 1, v24
    v_add_u32 v31, v24, v3
    v_add_u32 v15, 64, v14
    v_mul_u32_u24 v24, 0xcccd, v15
    v_lshrrev_b32 v24, 20, v24
    v_mul_u32_u24 v25, 20, v24
    v_sub_u32 v25, v15, v25
    v_mul_u32_u24 v24, 6144, v24
    v_lshl_add_u32 v24, v25, 1, v24
    v_add_u32 v32, v24, v3
    s_mov_b32 s44, 0x3ea52b5c
    s_cmp_eq_u32 s28, 0
    s_cselect_b32 s44, s44, 1.0
    v_mul_f32 v84, s44, v84
    v_mul_f32 v85, s44, v85
    v_mul_f32 v86, s44, v86
    v_mul_f32 v87, s44, v87
    v_cvt_pk_bf16_f32 v36, v84, v85
    v_cvt_pk_bf16_f32 v37, v86, v87
    ds_write_b64 v28, v[36:37] offset:0
    v_mul_f32 v88, s44, v88
    v_mul_f32 v89, s44, v89
    v_mul_f32 v90, s44, v90
    v_mul_f32 v91, s44, v91
    v_cvt_pk_bf16_f32 v38, v88, v89
    v_cvt_pk_bf16_f32 v39, v90, v91
    ds_write_b64 v29, v[38:39] offset:0
    v_mul_f32 v92, s44, v92
    v_mul_f32 v93, s44, v93
    v_mul_f32 v94, s44, v94
    v_mul_f32 v95, s44, v95
    v_cvt_pk_bf16_f32 v40, v92, v93
    v_cvt_pk_bf16_f32 v41, v94, v95
    ds_write_b64 v30, v[40:41] offset:0
    v_mul_f32 v96, s44, v96
    v_mul_f32 v97, s44, v97
    v_mul_f32 v98, s44, v98
    v_mul_f32 v99, s44, v99
    v_cvt_pk_bf16_f32 v42, v96, v97
    v_cvt_pk_bf16_f32 v43, v98, v99
    ds_write_b64 v31, v[42:43] offset:0
    v_mul_f32 v100, s44, v100
    v_mul_f32 v101, s44, v101
    v_mul_f32 v102, s44, v102
    v_mul_f32 v103, s44, v103
    v_cvt_pk_bf16_f32 v36, v100, v101
    v_cvt_pk_bf16_f32 v37, v102, v103
    ds_write_b64 v32, v[36:37] offset:0
    v_mul_f32 v104, s44, v104
    v_mul_f32 v105, s44, v105
    v_mul_f32 v106, s44, v106
    v_mul_f32 v107, s44, v107
    v_cvt_pk_bf16_f32 v38, v104, v105
    v_cvt_pk_bf16_f32 v39, v106, v107
    ds_write_b64 v28, v[38:39] offset:768
    v_mul_f32 v108, s44, v108
    v_mul_f32 v109, s44, v109
    v_mul_f32 v110, s44, v110
    v_mul_f32 v111, s44, v111
    v_cvt_pk_bf16_f32 v40, v108, v109
    v_cvt_pk_bf16_f32 v41, v110, v111
    ds_write_b64 v29, v[40:41] offset:768
    v_mul_f32 v112, s44, v112
    v_mul_f32 v113, s44, v113
    v_mul_f32 v114, s44, v114
    v_mul_f32 v115, s44, v115
    v_cvt_pk_bf16_f32 v42, v112, v113
    v_cvt_pk_bf16_f32 v43, v114, v115
    ds_write_b64 v30, v[42:43] offset:768
    v_mul_f32 v116, s44, v116
    v_mul_f32 v117, s44, v117
    v_mul_f32 v118, s44, v118
    v_mul_f32 v119, s44, v119
    v_cvt_pk_bf16_f32 v36, v116, v117
    v_cvt_pk_bf16_f32 v37, v118, v119
    ds_write_b64 v31, v[36:37] offset:768
    v_mul_f32 v120, s44, v120
    v_mul_f32 v121, s44, v121
    v_mul_f32 v122, s44, v122
    v_mul_f32 v123, s44, v123
    v_cvt_pk_bf16_f32 v38, v120, v121
    v_cvt_pk_bf16_f32 v39, v122, v123
    ds_write_b64 v32, v[38:39] offset:768
    s_movk_i32 s45, 6144
    s_mul_i32 s46, s29, 98304
    s_mul_i32 s48, s27, 48
    s_add_u32 s46, s46, s48
    s_add_u32 s46, s46, 0x0
    s_mul_i32 s48, s29, 196608
    s_lshr_b32 s49, s27, 8
    s_mul_i32 s49, s49, 24576
    s_add_u32 s48, s48, s49
    s_and_b32 s49, s27, 255
    s_mul_i32 s49, s49, 48
    s_add_u32 s48, s48, s49
    s_add_u32 s48, s48, 0x300000
    s_cmp_eq_u32 s28, 0
    s_cselect_b32 s46, s46, s48
    s_mov_b32 s48, 196608
    s_cselect_b32 s47, 98304, s48
    s_branch P1_COPY
.p2align 6
P1_LOOP_V:
    s_waitcnt lgkmcnt(0)
    v_mfma_f32_16x16x32_bf16 v[84:87], v[28:31], v[36:39], v[84:87]
    ds_read_b128 v[56:59], v21 offset:0
    ds_read_b64_tr_b16 v[64:65], v22 offset:10240
    v_mfma_f32_16x16x32_bf16 v[104:107], v[32:35], v[36:39], v[104:107]
    ds_read_b64_tr_b16 v[66:67], v22 offset:11520
    ds_read_b128 v[60:63], v21 offset:2048
    v_mfma_f32_16x16x32_bf16 v[88:91], v[28:31], v[40:43], v[88:91]
    ds_read_b64_tr_b16 v[68:69], v23 offset:10272
    v_mfma_f32_16x16x32_bf16 v[108:111], v[32:35], v[40:43], v[108:111]
    ds_read_b64_tr_b16 v[70:71], v23 offset:11552
    v_mfma_f32_16x16x32_bf16 v[92:95], v[28:31], v[44:47], v[92:95]
    ds_read_b64_tr_b16 v[72:73], v22 offset:10304
    v_mfma_f32_16x16x32_bf16 v[112:115], v[32:35], v[44:47], v[112:115]
    ds_read_b64_tr_b16 v[74:75], v22 offset:11584
    v_mfma_f32_16x16x32_bf16 v[96:99], v[28:31], v[48:51], v[96:99]
    ds_read_b64_tr_b16 v[76:77], v23 offset:10336
    v_mfma_f32_16x16x32_bf16 v[116:119], v[32:35], v[48:51], v[116:119]
    ds_read_b64_tr_b16 v[78:79], v23 offset:11616
    v_mfma_f32_16x16x32_bf16 v[100:103], v[28:31], v[52:55], v[100:103]
    ds_read_b64_tr_b16 v[80:81], v22 offset:10368
    v_mfma_f32_16x16x32_bf16 v[120:123], v[32:35], v[52:55], v[120:123]
    ds_read_b64_tr_b16 v[82:83], v22 offset:11648
    s_add_u32 s33, s33, 36864
    s_cmp_ge_u32 s33, 147456
    s_cselect_b32 s33, 0, s33
    s_waitcnt lgkmcnt(0)
    s_barrier
    v_add_u32 v20, s33, v16
    v_add_u32 v21, s33, v17
    v_add_u32 v22, s33, v18
    v_add_u32 v23, s33, v19
    s_waitcnt lgkmcnt(0)
    v_mfma_f32_16x16x32_bf16 v[84:87], v[56:59], v[64:67], v[84:87]
    ds_read_b128 v[28:31], v20 offset:0
    ds_read_b64_tr_b16 v[36:37], v22 offset:0
    v_mfma_f32_16x16x32_bf16 v[104:107], v[60:63], v[64:67], v[104:107]
    ds_read_b64_tr_b16 v[38:39], v22 offset:1280
    ds_read_b128 v[32:35], v20 offset:2048
    v_mfma_f32_16x16x32_bf16 v[88:91], v[56:59], v[68:71], v[88:91]
    ds_read_b64_tr_b16 v[40:41], v23 offset:32
    v_mfma_f32_16x16x32_bf16 v[108:111], v[60:63], v[68:71], v[108:111]
    ds_read_b64_tr_b16 v[42:43], v23 offset:1312
    v_mfma_f32_16x16x32_bf16 v[92:95], v[56:59], v[72:75], v[92:95]
    ds_read_b64_tr_b16 v[44:45], v22 offset:64
    v_mfma_f32_16x16x32_bf16 v[112:115], v[60:63], v[72:75], v[112:115]
    ds_read_b64_tr_b16 v[46:47], v22 offset:1344
    v_mfma_f32_16x16x32_bf16 v[96:99], v[56:59], v[76:79], v[96:99]
    ds_read_b64_tr_b16 v[48:49], v23 offset:96
    v_mfma_f32_16x16x32_bf16 v[116:119], v[60:63], v[76:79], v[116:119]
    ds_read_b64_tr_b16 v[50:51], v23 offset:1376
    v_mfma_f32_16x16x32_bf16 v[100:103], v[56:59], v[80:83], v[100:103]
    ds_read_b64_tr_b16 v[52:53], v22 offset:128
    v_mfma_f32_16x16x32_bf16 v[120:123], v[60:63], v[80:83], v[120:123]
    ds_read_b64_tr_b16 v[54:55], v22 offset:1408
    s_add_u32 s34, s34, 1
    s_cmp_lt_u32 s34, 10
    s_cbranch_scc1 P1_LOOP_V
    s_waitcnt lgkmcnt(0)
    s_barrier
    s_cmp_eq_u32 s51, 0
    s_cbranch_scc1 P1_LOOP_V_NH
    s_mov_b32 s20, s70
    s_and_b32 s21, s71, 0xffff
    s_mov_b32 s22, 0x280000
    s_mov_b32 s23, 0x00020000
    s_lshl_b32 s17, s50, 12
    v_lshlrev_b32 v148, 4, v1
    buffer_load_dwordx4 v[124:127], v148, s[20:23], s17 offen offset:0 nt
    buffer_load_dwordx4 v[128:131], v148, s[20:23], s17 offen offset:1024 nt
    buffer_load_dwordx4 v[132:135], v148, s[20:23], s17 offen offset:2048 nt
    buffer_load_dwordx4 v[136:139], v148, s[20:23], s17 offen offset:3072 nt
    buffer_load_dwordx2 v[140:141], v148, s[20:23], s17 offen offset:16 nt
    buffer_load_dwordx2 v[142:143], v148, s[20:23], s17 offen offset:1040 nt
    buffer_load_dwordx2 v[144:145], v148, s[20:23], s17 offen offset:2064 nt
    buffer_load_dwordx2 v[146:147], v148, s[20:23], s17 offen offset:3088 nt
P1_LOOP_V_NH:
    s_mul_i32 s35, s11, 80
    v_lshrrev_b32 v3, 1, v13
    s_lshl_b32 s44, s10, 2
    v_add_u32 v3, s44, v3
    v_mul_u32_u24 v3, 352, v3
    v_and_b32 v14, 1, v13
    v_lshl_add_u32 v3, v14, 3, v3
    v_add_u32 v14, s35, v2
    v_add_u32 v15, 0, v14
    v_mul_u32_u24 v24, 0xcccd, v15
    v_lshrrev_b32 v24, 20, v24
    v_mul_u32_u24 v25, 20, v24
    v_sub_u32 v25, v15, v25
    v_mul_u32_u24 v24, 5632, v24
    v_lshl_add_u32 v24, v25, 4, v24
    v_add_u32 v28, v24, v3
    v_add_u32 v15, 16, v14
    v_mul_u32_u24 v24, 0xcccd, v15
    v_lshrrev_b32 v24, 20, v24
    v_mul_u32_u24 v25, 20, v24
    v_sub_u32 v25, v15, v25
    v_mul_u32_u24 v24, 5632, v24
    v_lshl_add_u32 v24, v25, 4, v24
    v_add_u32 v29, v24, v3
    v_add_u32 v15, 32, v14
    v_mul_u32_u24 v24, 0xcccd, v15
    v_lshrrev_b32 v24, 20, v24
    v_mul_u32_u24 v25, 20, v24
    v_sub_u32 v25, v15, v25
    v_mul_u32_u24 v24, 5632, v24
    v_lshl_add_u32 v24, v25, 4, v24
    v_add_u32 v30, v24, v3
    v_add_u32 v15, 48, v14
    v_mul_u32_u24 v24, 0xcccd, v15
    v_lshrrev_b32 v24, 20, v24
    v_mul_u32_u24 v25, 20, v24
    v_sub_u32 v25, v15, v25
    v_mul_u32_u24 v24, 5632, v24
    v_lshl_add_u32 v24, v25, 4, v24
    v_add_u32 v31, v24, v3
    v_add_u32 v15, 64, v14
    v_mul_u32_u24 v24, 0xcccd, v15
    v_lshrrev_b32 v24, 20, v24
    v_mul_u32_u24 v25, 20, v24
    v_sub_u32 v25, v15, v25
    v_mul_u32_u24 v24, 5632, v24
    v_lshl_add_u32 v24, v25, 4, v24
    v_add_u32 v32, v24, v3
    v_cvt_pk_bf16_f32 v36, v84, v85
    v_cvt_pk_bf16_f32 v37, v86, v87
    ds_write_b64 v28, v[36:37] offset:0
    v_cvt_pk_bf16_f32 v38, v88, v89
    v_cvt_pk_bf16_f32 v39, v90, v91
    ds_write_b64 v29, v[38:39] offset:0
    v_cvt_pk_bf16_f32 v40, v92, v93
    v_cvt_pk_bf16_f32 v41, v94, v95
    ds_write_b64 v30, v[40:41] offset:0
    v_cvt_pk_bf16_f32 v42, v96, v97
    v_cvt_pk_bf16_f32 v43, v98, v99
    ds_write_b64 v31, v[42:43] offset:0
    v_cvt_pk_bf16_f32 v36, v100, v101
    v_cvt_pk_bf16_f32 v37, v102, v103
    ds_write_b64 v32, v[36:37] offset:0
    v_cvt_pk_bf16_f32 v38, v104, v105
    v_cvt_pk_bf16_f32 v39, v106, v107
    ds_write_b64 v28, v[38:39] offset:704
    v_cvt_pk_bf16_f32 v40, v108, v109
    v_cvt_pk_bf16_f32 v41, v110, v111
    ds_write_b64 v29, v[40:41] offset:704
    v_cvt_pk_bf16_f32 v42, v112, v113
    v_cvt_pk_bf16_f32 v43, v114, v115
    ds_write_b64 v30, v[42:43] offset:704
    v_cvt_pk_bf16_f32 v36, v116, v117
    v_cvt_pk_bf16_f32 v37, v118, v119
    ds_write_b64 v31, v[36:37] offset:704
    v_cvt_pk_bf16_f32 v38, v120, v121
    v_cvt_pk_bf16_f32 v39, v122, v123
    ds_write_b64 v32, v[38:39] offset:704
    s_mul_i32 s44, s26, 5632
    v_mul_u32_u24 v14, 352, v1
    v_add_u32 v3, s44, v14
    v_mov_b32 v44, 0x3f803f80
    v_mov_b32 v48, 0
    v_mov_b32 v45, 0x3f803f80
    v_mov_b32 v49, 0
    v_mov_b32 v46, 0x3f803f80
    v_mov_b32 v50, 0
    v_mov_b32 v47, 0x3f803f80
    v_mov_b32 v51, 0
    s_mov_b64 exec, 0xffff
    ds_write_b128 v3, v[44:47] offset:320
    ds_write_b128 v3, v[48:51] offset:336
    s_mov_b64 exec, -1
    s_movk_i32 s45, 5632
    s_mul_i32 s46, s29, 196608
    s_lshr_b32 s49, s27, 8
    s_mul_i32 s49, s49, 24576
    s_add_u32 s46, s46, s49
    s_and_b32 s49, s27, 255
    s_mul_i32 s49, s49, 44
    s_add_u32 s46, s46, s49
    s_add_u32 s46, s46, 0x303000
    s_mov_b32 s47, 196608
P1_COPY:
    s_waitcnt lgkmcnt(0)
    s_barrier
    s_cmp_lt_u32 s26, 4
    s_cbranch_scc1 P15_CONV
    v_lshlrev_b32 v2, 4, v1
    s_sub_u32 s10, s26, 4
    s_lshl_b32 s10, s10, 1
    s_mul_i32 s11, s10, s45
    s_mul_i32 s48, s10, s47
    s_add_u32 s46, s46, s48
    v_add_u32 v3, s11, v2
    v_add_u32 v14, s45, v3
    s_add_u32 s48, s46, s47
    s_add_u32 s49, s46, 4096
    s_add_u32 s38, s48, 4096
    ds_read_b128 v[28:31], v3 offset:0
    ds_read_b128 v[32:35], v3 offset:1024
    ds_read_b128 v[36:39], v3 offset:2048
    ds_read_b128 v[40:43], v3 offset:3072
    ds_read_b128 v[44:47], v3 offset:4096
    ds_read_b128 v[48:51], v3 offset:5120
    ds_read_b128 v[52:55], v14 offset:0
    ds_read_b128 v[56:59], v14 offset:1024
    ds_read_b128 v[60:63], v14 offset:2048
    ds_read_b128 v[64:67], v14 offset:3072
    ds_read_b128 v[68:71], v14 offset:4096
    ds_read_b128 v[72:75], v14 offset:5120
    v_add_u32 v15, 5120, v2
    v_cmp_gt_u32 vcc, s45, v15
    s_waitcnt lgkmcnt(11)
    buffer_store_dwordx4 v[28:31], v2, s[12:15], s46 offen offset:0 sc1
    s_waitcnt lgkmcnt(10)
    buffer_store_dwordx4 v[32:35], v2, s[12:15], s46 offen offset:1024 sc1
    s_waitcnt lgkmcnt(9)
    buffer_store_dwordx4 v[36:39], v2, s[12:15], s46 offen offset:2048 sc1
    s_waitcnt lgkmcnt(8)
    buffer_store_dwordx4 v[40:43], v2, s[12:15], s46 offen offset:3072 sc1
    s_waitcnt lgkmcnt(7)
    buffer_store_dwordx4 v[44:47], v2, s[12:15], s49 offen offset:0 sc1
    s_waitcnt lgkmcnt(5)
    buffer_store_dwordx4 v[52:55], v2, s[12:15], s48 offen offset:0 sc1
    s_waitcnt lgkmcnt(4)
    buffer_store_dwordx4 v[56:59], v2, s[12:15], s48 offen offset:1024 sc1
    s_waitcnt lgkmcnt(3)
    buffer_store_dwordx4 v[60:63], v2, s[12:15], s48 offen offset:2048 sc1
    s_waitcnt lgkmcnt(2)
    buffer_store_dwordx4 v[64:67], v2, s[12:15], s48 offen offset:3072 sc1
    s_waitcnt lgkmcnt(1)
    buffer_store_dwordx4 v[68:71], v2, s[12:15], s38 offen offset:0 sc1
    s_waitcnt lgkmcnt(0)
    s_and_saveexec_b64 s[36:37], vcc
    buffer_store_dwordx4 v[48:51], v2, s[12:15], s49 offen offset:1024 sc1
    buffer_store_dwordx4 v[72:75], v2, s[12:15], s38 offen offset:1024 sc1
    s_mov_b64 exec, s[36:37]
    s_branch P1_SIGNAL
P1_E:
    s_sub_u32 s24, s2, 192
    s_mov_b32 s55, s2
    s_cmp_ge_u32 s26, 10
    s_cbranch_scc1 P1_E_B1
    s_mov_b32 s16, s64
    s_and_b32 s17, s65, 0xffff
    s_mov_b32 s18, 0x280000
    s_mov_b32 s19, 0x00020000
    s_mov_b32 s20, s66
    s_and_b32 s21, s67, 0xffff
    s_mov_b32 s22, 0x280000
    s_mov_b32 s23, 0x00020000
    s_mov_b32 s44, s68
    s_and_b32 s45, s69, 0xffff
    s_mov_b32 s46, 0x1400
    s_mov_b32 s47, 0x00020000
    s_lshl_b32 s25, s24, 5
    s_movk_i32 s27, 5120
    s_movk_i32 s28, 1280
    v_mul_u32_u24 v3, 0xcccd, v0
    v_lshrrev_b32 v3, 23, v3
    v_mul_u32_u24 v4, 160, v3
    v_sub_u32 v4, v0, v4
    v_lshlrev_b32 v5, 3, v3
    v_add_u32 v5, s25, v5
    v_mul_lo_u32 v6, v5, s28
    v_lshl_add_u32 v6, v4, 3, v6
    v_subrev_u32 v7, 3840, v6
    v_cmp_eq_u32 vcc, 0, v5
    v_mov_b32 v8, 0x7f000000
    v_lshlrev_b32 v9, 5, v4
    v_cndmask_b32 v7, v7, v8, vcc
    v_mul_u32_u24 v10, 320, v4
    v_sub_u32 v11, 3, v3
    v_lshl_add_u32 v54, v11, 4, v10
    buffer_load_dwordx2 v[16:17], v7, s[16:19], 0 offen offset:0 nt
    buffer_load_dwordx2 v[18:19], v7, s[16:19], 0 offen offset:1280 nt
    buffer_load_dwordx2 v[20:21], v7, s[16:19], 0 offen offset:2560 nt
    buffer_load_dwordx2 v[22:23], v6, s[16:19], 0 offen offset:0 nt
    buffer_load_dwordx2 v[24:25], v6, s[16:19], 0 offen offset:1280 nt
    buffer_load_dwordx2 v[26:27], v6, s[16:19], 0 offen offset:2560 nt
    buffer_load_dwordx2 v[28:29], v6, s[16:19], 0 offen offset:3840 nt
    buffer_load_dwordx2 v[30:31], v6, s[16:19], s27 offen offset:0 nt
    buffer_load_dwordx2 v[32:33], v6, s[16:19], s27 offen offset:1280 nt
    buffer_load_dwordx2 v[34:35], v6, s[16:19], s27 offen offset:2560 nt
    buffer_load_dwordx2 v[36:37], v6, s[16:19], s27 offen offset:3840 nt
    buffer_load_dwordx2 v[38:39], v6, s[20:23], 0 offen offset:0 nt
    buffer_load_dwordx2 v[40:41], v6, s[20:23], 0 offen offset:1280 nt
    buffer_load_dwordx2 v[42:43], v6, s[20:23], 0 offen offset:2560 nt
    buffer_load_dwordx2 v[44:45], v6, s[20:23], 0 offen offset:3840 nt
    buffer_load_dwordx2 v[46:47], v6, s[20:23], s27 offen offset:0 nt
    buffer_load_dwordx2 v[48:49], v6, s[20:23], s27 offen offset:1280 nt
    buffer_load_dwordx2 v[50:51], v6, s[20:23], s27 offen offset:2560 nt
    buffer_load_dwordx2 v[52:53], v6, s[20:23], s27 offen offset:3840 nt
    buffer_load_dwordx4 v[56:59], v9, s[44:47], 0 offen
    buffer_load_dwordx4 v[60:63], v9, s[44:47], 0 offen offset:16
    s_mov_b32 s29, 0xffff0000
    s_waitcnt vmcnt(0)
    s_cmp_ge_u32 s26, 8
    s_cbranch_scc1 P1_E_NOH
    s_lshl_b32 s17, s26, 2
    s_or_b32 s17, s17, 0x40000
    s_and_b32 s18, s2, 1
    s_mov_b32 s51, 0x20002111
    s_cmp_eq_u32 s18, 0
    s_cselect_b32 s51, s51, 0x2002211
    s_bfe_u32 s51, s51, s17
    s_mov_b32 s50, 0x10000210
    s_cmp_eq_u32 s18, 0
    s_cselect_b32 s50, s50, 0x3004243
    s_bfe_u32 s50, s50, s17
    s_mov_b32 s16, 0x30003210
    s_cmp_eq_u32 s18, 0
    s_cselect_b32 s16, s16, 0x2002210
    s_bfe_u32 s16, s16, s17
    s_mov_b32 s19, 0x10000000
    s_cmp_eq_u32 s18, 0
    s_cselect_b32 s19, s19, 0x1002000
    s_bfe_u32 s19, s19, s17
    s_lshr_b32 s18, s2, 1
    s_mul_i32 s18, s18, 5
    s_add_u32 s50, s50, s18
    s_mul_i32 s16, s16, 24240
    s_mul_i32 s19, s19, 13488
    s_add_u32 s16, s16, s19
    s_add_u32 s16, s16, 51200
    s_cmp_eq_u32 s51, 0
    s_cbranch_scc1 P1_E_NOH
    s_mov_b32 s20, s70
    s_and_b32 s21, s71, 0xffff
    s_mov_b32 s22, 0x280000
    s_mov_b32 s23, 0x00020000
    s_lshl_b32 s17, s50, 12
    v_lshlrev_b32 v148, 4, v1
    buffer_load_dwordx4 v[124:127], v148, s[20:23], s17 offen offset:0 nt
    buffer_load_dwordx4 v[128:131], v148, s[20:23], s17 offen offset:1024 nt
    buffer_load_dwordx4 v[132:135], v148, s[20:23], s17 offen offset:2048 nt
    buffer_load_dwordx4 v[136:139], v148, s[20:23], s17 offen offset:3072 nt
    buffer_load_dwordx2 v[140:141], v148, s[20:23], s17 offen offset:16 nt
    buffer_load_dwordx2 v[142:143], v148, s[20:23], s17 offen offset:1040 nt
    buffer_load_dwordx2 v[144:145], v148, s[20:23], s17 offen offset:2064 nt
    buffer_load_dwordx2 v[146:147], v148, s[20:23], s17 offen offset:3088 nt
P1_E_NOH:
    v_lshlrev_b32 v64, 16, v16
    v_lshlrev_b32 v65, 16, v18
    v_lshlrev_b32 v66, 16, v20
    v_lshlrev_b32 v67, 16, v22
    v_lshlrev_b32 v68, 16, v24
    v_lshlrev_b32 v69, 16, v26
    v_lshlrev_b32 v70, 16, v28
    v_lshlrev_b32 v71, 16, v30
    v_lshlrev_b32 v72, 16, v32
    v_lshlrev_b32 v73, 16, v34
    v_lshlrev_b32 v74, 16, v36
    v_lshlrev_b32 v75, 16, v56
    v_and_b32 v76, s29, v56
    v_lshlrev_b32 v77, 16, v57
    v_and_b32 v78, s29, v57
    v_mul_f32 v4, v78, v64
    v_fmac_f32 v4, v77, v65
    v_fmac_f32 v4, v76, v66
    v_fmac_f32 v4, v75, v67
    v_lshlrev_b32 v79, 16, v38
    v_mul_f32 v4, v4, v79
    v_mul_f32 v5, v78, v65
    v_fmac_f32 v5, v77, v66
    v_fmac_f32 v5, v76, v67
    v_fmac_f32 v5, v75, v68
    v_lshlrev_b32 v79, 16, v40
    v_mul_f32 v5, v5, v79
    v_mul_f32 v6, v78, v66
    v_fmac_f32 v6, v77, v67
    v_fmac_f32 v6, v76, v68
    v_fmac_f32 v6, v75, v69
    v_lshlrev_b32 v79, 16, v42
    v_mul_f32 v6, v6, v79
    v_mul_f32 v7, v78, v67
    v_fmac_f32 v7, v77, v68
    v_fmac_f32 v7, v76, v69
    v_fmac_f32 v7, v75, v70
    v_lshlrev_b32 v79, 16, v44
    v_mul_f32 v7, v7, v79
    v_mul_f32 v8, v78, v68
    v_fmac_f32 v8, v77, v69
    v_fmac_f32 v8, v76, v70
    v_fmac_f32 v8, v75, v71
    v_lshlrev_b32 v79, 16, v46
    v_mul_f32 v8, v8, v79
    v_mul_f32 v9, v78, v69
    v_fmac_f32 v9, v77, v70
    v_fmac_f32 v9, v76, v71
    v_fmac_f32 v9, v75, v72
    v_lshlrev_b32 v79, 16, v48
    v_mul_f32 v9, v9, v79
    v_mul_f32 v10, v78, v70
    v_fmac_f32 v10, v77, v71
    v_fmac_f32 v10, v76, v72
    v_fmac_f32 v10, v75, v73
    v_lshlrev_b32 v79, 16, v50
    v_mul_f32 v10, v10, v79
    v_mul_f32 v11, v78, v71
    v_fmac_f32 v11, v77, v72
    v_fmac_f32 v11, v76, v73
    v_fmac_f32 v11, v75, v74
    v_lshlrev_b32 v79, 16, v52
    v_mul_f32 v11, v11, v79
    v_cvt_pk_bf16_f32 v12, v11, v10
    v_cvt_pk_bf16_f32 v13, v9, v8
    v_cvt_pk_bf16_f32 v14, v7, v6
    v_cvt_pk_bf16_f32 v15, v5, v4
    ds_write_b128 v54, v[12:15] offset:0
    s_nop 0
    v_and_b32 v64, s29, v16
    v_and_b32 v65, s29, v18
    v_and_b32 v66, s29, v20
    v_and_b32 v67, s29, v22
    v_and_b32 v68, s29, v24
    v_and_b32 v69, s29, v26
    v_and_b32 v70, s29, v28
    v_and_b32 v71, s29, v30
    v_and_b32 v72, s29, v32
    v_and_b32 v73, s29, v34
    v_and_b32 v74, s29, v36
    v_lshlrev_b32 v75, 16, v58
    v_and_b32 v76, s29, v58
    v_lshlrev_b32 v77, 16, v59
    v_and_b32 v78, s29, v59
    v_mul_f32 v4, v78, v64
    v_fmac_f32 v4, v77, v65
    v_fmac_f32 v4, v76, v66
    v_fmac_f32 v4, v75, v67
    v_and_b32 v79, s29, v38
    v_mul_f32 v4, v4, v79
    v_mul_f32 v5, v78, v65
    v_fmac_f32 v5, v77, v66
    v_fmac_f32 v5, v76, v67
    v_fmac_f32 v5, v75, v68
    v_and_b32 v79, s29, v40
    v_mul_f32 v5, v5, v79
    v_mul_f32 v6, v78, v66
    v_fmac_f32 v6, v77, v67
    v_fmac_f32 v6, v76, v68
    v_fmac_f32 v6, v75, v69
    v_and_b32 v79, s29, v42
    v_mul_f32 v6, v6, v79
    v_mul_f32 v7, v78, v67
    v_fmac_f32 v7, v77, v68
    v_fmac_f32 v7, v76, v69
    v_fmac_f32 v7, v75, v70
    v_and_b32 v79, s29, v44
    v_mul_f32 v7, v7, v79
    v_mul_f32 v8, v78, v68
    v_fmac_f32 v8, v77, v69
    v_fmac_f32 v8, v76, v70
    v_fmac_f32 v8, v75, v71
    v_and_b32 v79, s29, v46
    v_mul_f32 v8, v8, v79
    v_mul_f32 v9, v78, v69
    v_fmac_f32 v9, v77, v70
    v_fmac_f32 v9, v76, v71
    v_fmac_f32 v9, v75, v72
    v_and_b32 v79, s29, v48
    v_mul_f32 v9, v9, v79
    v_mul_f32 v10, v78, v70
    v_fmac_f32 v10, v77, v71
    v_fmac_f32 v10, v76, v72
    v_fmac_f32 v10, v75, v73
    v_and_b32 v79, s29, v50
    v_mul_f32 v10, v10, v79
    v_mul_f32 v11, v78, v71
    v_fmac_f32 v11, v77, v72
    v_fmac_f32 v11, v76, v73
    v_fmac_f32 v11, v75, v74
    v_and_b32 v79, s29, v52
    v_mul_f32 v11, v11, v79
    v_cvt_pk_bf16_f32 v12, v11, v10
    v_cvt_pk_bf16_f32 v13, v9, v8
    v_cvt_pk_bf16_f32 v14, v7, v6
    v_cvt_pk_bf16_f32 v15, v5, v4
    ds_write_b128 v54, v[12:15] offset:80
    s_nop 0
    v_lshlrev_b32 v64, 16, v17
    v_lshlrev_b32 v65, 16, v19
    v_lshlrev_b32 v66, 16, v21
    v_lshlrev_b32 v67, 16, v23
    v_lshlrev_b32 v68, 16, v25
    v_lshlrev_b32 v69, 16, v27
    v_lshlrev_b32 v70, 16, v29
    v_lshlrev_b32 v71, 16, v31
    v_lshlrev_b32 v72, 16, v33
    v_lshlrev_b32 v73, 16, v35
    v_lshlrev_b32 v74, 16, v37
    v_lshlrev_b32 v75, 16, v60
    v_and_b32 v76, s29, v60
    v_lshlrev_b32 v77, 16, v61
    v_and_b32 v78, s29, v61
    v_mul_f32 v4, v78, v64
    v_fmac_f32 v4, v77, v65
    v_fmac_f32 v4, v76, v66
    v_fmac_f32 v4, v75, v67
    v_lshlrev_b32 v79, 16, v39
    v_mul_f32 v4, v4, v79
    v_mul_f32 v5, v78, v65
    v_fmac_f32 v5, v77, v66
    v_fmac_f32 v5, v76, v67
    v_fmac_f32 v5, v75, v68
    v_lshlrev_b32 v79, 16, v41
    v_mul_f32 v5, v5, v79
    v_mul_f32 v6, v78, v66
    v_fmac_f32 v6, v77, v67
    v_fmac_f32 v6, v76, v68
    v_fmac_f32 v6, v75, v69
    v_lshlrev_b32 v79, 16, v43
    v_mul_f32 v6, v6, v79
    v_mul_f32 v7, v78, v67
    v_fmac_f32 v7, v77, v68
    v_fmac_f32 v7, v76, v69
    v_fmac_f32 v7, v75, v70
    v_lshlrev_b32 v79, 16, v45
    v_mul_f32 v7, v7, v79
    v_mul_f32 v8, v78, v68
    v_fmac_f32 v8, v77, v69
    v_fmac_f32 v8, v76, v70
    v_fmac_f32 v8, v75, v71
    v_lshlrev_b32 v79, 16, v47
    v_mul_f32 v8, v8, v79
    v_mul_f32 v9, v78, v69
    v_fmac_f32 v9, v77, v70
    v_fmac_f32 v9, v76, v71
    v_fmac_f32 v9, v75, v72
    v_lshlrev_b32 v79, 16, v49
    v_mul_f32 v9, v9, v79
    v_mul_f32 v10, v78, v70
    v_fmac_f32 v10, v77, v71
    v_fmac_f32 v10, v76, v72
    v_fmac_f32 v10, v75, v73
    v_lshlrev_b32 v79, 16, v51
    v_mul_f32 v10, v10, v79
    v_mul_f32 v11, v78, v71
    v_fmac_f32 v11, v77, v72
    v_fmac_f32 v11, v76, v73
    v_fmac_f32 v11, v75, v74
    v_lshlrev_b32 v79, 16, v53
    v_mul_f32 v11, v11, v79
    v_cvt_pk_bf16_f32 v12, v11, v10
    v_cvt_pk_bf16_f32 v13, v9, v8
    v_cvt_pk_bf16_f32 v14, v7, v6
    v_cvt_pk_bf16_f32 v15, v5, v4
    ds_write_b128 v54, v[12:15] offset:160
    s_nop 0
    v_and_b32 v64, s29, v17
    v_and_b32 v65, s29, v19
    v_and_b32 v66, s29, v21
    v_and_b32 v67, s29, v23
    v_and_b32 v68, s29, v25
    v_and_b32 v69, s29, v27
    v_and_b32 v70, s29, v29
    v_and_b32 v71, s29, v31
    v_and_b32 v72, s29, v33
    v_and_b32 v73, s29, v35
    v_and_b32 v74, s29, v37
    v_lshlrev_b32 v75, 16, v62
    v_and_b32 v76, s29, v62
    v_lshlrev_b32 v77, 16, v63
    v_and_b32 v78, s29, v63
    v_mul_f32 v4, v78, v64
    v_fmac_f32 v4, v77, v65
    v_fmac_f32 v4, v76, v66
    v_fmac_f32 v4, v75, v67
    v_and_b32 v79, s29, v39
    v_mul_f32 v4, v4, v79
    v_mul_f32 v5, v78, v65
    v_fmac_f32 v5, v77, v66
    v_fmac_f32 v5, v76, v67
    v_fmac_f32 v5, v75, v68
    v_and_b32 v79, s29, v41
    v_mul_f32 v5, v5, v79
    v_mul_f32 v6, v78, v66
    v_fmac_f32 v6, v77, v67
    v_fmac_f32 v6, v76, v68
    v_fmac_f32 v6, v75, v69
    v_and_b32 v79, s29, v43
    v_mul_f32 v6, v6, v79
    v_mul_f32 v7, v78, v67
    v_fmac_f32 v7, v77, v68
    v_fmac_f32 v7, v76, v69
    v_fmac_f32 v7, v75, v70
    v_and_b32 v79, s29, v45
    v_mul_f32 v7, v7, v79
    v_mul_f32 v8, v78, v68
    v_fmac_f32 v8, v77, v69
    v_fmac_f32 v8, v76, v70
    v_fmac_f32 v8, v75, v71
    v_and_b32 v79, s29, v47
    v_mul_f32 v8, v8, v79
    v_mul_f32 v9, v78, v69
    v_fmac_f32 v9, v77, v70
    v_fmac_f32 v9, v76, v71
    v_fmac_f32 v9, v75, v72
    v_and_b32 v79, s29, v49
    v_mul_f32 v9, v9, v79
    v_mul_f32 v10, v78, v70
    v_fmac_f32 v10, v77, v71
    v_fmac_f32 v10, v76, v72
    v_fmac_f32 v10, v75, v73
    v_and_b32 v79, s29, v51
    v_mul_f32 v10, v10, v79
    v_mul_f32 v11, v78, v71
    v_fmac_f32 v11, v77, v72
    v_fmac_f32 v11, v76, v73
    v_fmac_f32 v11, v75, v74
    v_and_b32 v79, s29, v53
    v_mul_f32 v11, v11, v79
    v_cvt_pk_bf16_f32 v12, v11, v10
    v_cvt_pk_bf16_f32 v13, v9, v8
    v_cvt_pk_bf16_f32 v14, v7, v6
    v_cvt_pk_bf16_f32 v15, v5, v4
    ds_write_b128 v54, v[12:15] offset:240
    s_nop 0
    s_waitcnt lgkmcnt(0)
P1_E_B1:
    s_cmp_lt_u32 s26, 8
    s_cbranch_scc1 P1_E_NON
    s_mov_b32 s36, s78
    s_and_b32 s37, s79, 0xffff
    s_mov_b32 s38, 0x100
    s_mov_b32 s39, 0x00020000
    v_mov_b32 v16, 0
    v_mov_b32 v18, 0
    v_mov_b32 v19, 0
    s_mov_b32 s58, 0
    s_branch NONC_24
NON_23:
    buffer_load_dwordx2 v[18:19], v16, s[36:39], 0 offen sc0 sc1
    s_waitcnt vmcnt(0)
NONC_24:
    v_readfirstlane_b32 s56, v18
    v_readfirstlane_b32 s57, v19
    s_add_u32 s58, s58, 1
    s_cmp_gt_u32 s58, 30000
    s_cbranch_scc1 NOND_25
    s_not_b32 s59, s56
    s_cmp_lg_u32 s59, s57
    s_cbranch_scc1 NON_23
NOND_25:
    v_mov_b32 v16, 163584
    v_mov_b32 v18, s56
    v_mov_b32 v19, s57
    ds_write_b64 v16, v[18:19]
    s_waitcnt lgkmcnt(0)
P1_E_NON:
    s_barrier
    s_cmp_lt_u32 s26, 4
    s_cbranch_scc1 P15_CONV
    s_cmp_lt_u32 s26, 8
    s_cbranch_scc1 P1_E_COPY
    v_lshlrev_b32 v20, 6, v1
    v_add_u32 v20, 0x1213000, v20
    v_mov_b32 v22, 0
    v_mov_b32 v23, 0
    s_mov_b32 s18, 40960
    v_add_u32 v24, 0, v1
    v_mul_u32_u24 v25, 0xcccd, v24
    v_lshrrev_b32 v25, 18, v25
    v_mul_u32_u24 v26, 5, v25
    v_sub_u32 v24, v24, v26
    v_min_u32 v24, 3, v24
    v_mul_lo_u32 v25, v25, s18
    v_lshl_add_u32 v28, v24, 4, v25
    v_add_u32 v24, 64, v1
    v_mul_u32_u24 v25, 0xcccd, v24
    v_lshrrev_b32 v25, 18, v25
    v_mul_u32_u24 v26, 5, v25
    v_sub_u32 v24, v24, v26
    v_min_u32 v24, 3, v24
    v_mul_lo_u32 v25, v25, s18
    v_lshl_add_u32 v29, v24, 4, v25
    v_add_u32 v24, 128, v1
    v_mul_u32_u24 v25, 0xcccd, v24
    v_lshrrev_b32 v25, 18, v25
    v_mul_u32_u24 v26, 5, v25
    v_sub_u32 v24, v24, v26
    v_min_u32 v24, 3, v24
    v_mul_lo_u32 v25, v25, s18
    v_lshl_add_u32 v30, v24, 4, v25
    v_add_u32 v24, 192, v1
    v_mul_u32_u24 v25, 0xcccd, v24
    v_lshrrev_b32 v25, 18, v25
    v_mul_u32_u24 v26, 5, v25
    v_sub_u32 v24, v24, v26
    v_min_u32 v24, 3, v24
    v_mul_lo_u32 v25, v25, s18
    v_lshl_add_u32 v31, v24, 4, v25
    v_add_u32 v24, 256, v1
    v_mul_u32_u24 v25, 0xcccd, v24
    v_lshrrev_b32 v25, 18, v25
    v_mul_u32_u24 v26, 5, v25
    v_sub_u32 v24, v24, v26
    v_min_u32 v24, 3, v24
    v_mul_lo_u32 v25, v25, s18
    v_lshl_add_u32 v32, v24, 4, v25
    s_sub_u32 s35, s26, 8
    s_lshl_b32 s17, s35, 2
    s_or_b32 s17, s17, 0x40000
    s_and_b32 s18, s2, 1
    s_mov_b32 s51, 0x20002111
    s_cmp_eq_u32 s18, 0
    s_cselect_b32 s51, s51, 0x2002211
    s_bfe_u32 s51, s51, s17
    s_mov_b32 s50, 0x10000210
    s_cmp_eq_u32 s18, 0
    s_cselect_b32 s50, s50, 0x3004243
    s_bfe_u32 s50, s50, s17
    s_mov_b32 s16, 0x30003210
    s_cmp_eq_u32 s18, 0
    s_cselect_b32 s16, s16, 0x2002210
    s_bfe_u32 s16, s16, s17
    s_mov_b32 s19, 0x10000000
    s_cmp_eq_u32 s18, 0
    s_cselect_b32 s19, s19, 0x1002000
    s_bfe_u32 s19, s19, s17
    s_lshr_b32 s18, s2, 1
    s_mul_i32 s18, s18, 5
    s_add_u32 s50, s50, s18
    s_mul_i32 s16, s16, 24240
    s_mul_i32 s19, s19, 13488
    s_add_u32 s16, s16, s19
    s_add_u32 s16, s16, 51200
    s_branch P1_HU
P1_E_COPY:
    v_lshrrev_b32 v2, 2, v1
    v_mul_u32_u24 v2, 80, v2
    v_and_b32 v3, 3, v1
    v_lshl_add_u32 v2, v3, 4, v2
    s_sub_u32 s11, s26, 4
    s_mul_i32 s10, s11, 12800
    v_add_u32 v2, s10, v2
    v_lshlrev_b32 v3, 4, v1
    s_sub_u32 s10, 63, s24
    s_mul_i32 s10, s10, 40960
    s_mul_i32 s11, s11, 10240
    s_add_u32 s10, s10, s11
    s_add_u32 s10, s10, 0x900000
    s_add_u32 s11, s10, 4096
    s_add_u32 s29, s10, 8192
    ds_read_b128 v[16:19], v2 offset:0
    ds_read_b128 v[20:23], v2 offset:1280
    ds_read_b128 v[24:27], v2 offset:2560
    ds_read_b128 v[28:31], v2 offset:3840
    ds_read_b128 v[32:35], v2 offset:5120
    ds_read_b128 v[36:39], v2 offset:6400
    ds_read_b128 v[40:43], v2 offset:7680
    ds_read_b128 v[44:47], v2 offset:8960
    ds_read_b128 v[48:51], v2 offset:10240
    ds_read_b128 v[52:55], v2 offset:11520
    s_waitcnt lgkmcnt(9)
    buffer_store_dwordx4 v[16:19], v3, s[12:15], s10 offen offset:0 sc1
    s_waitcnt lgkmcnt(8)
    buffer_store_dwordx4 v[20:23], v3, s[12:15], s10 offen offset:1024 sc1
    s_waitcnt lgkmcnt(7)
    buffer_store_dwordx4 v[24:27], v3, s[12:15], s10 offen offset:2048 sc1
    s_waitcnt lgkmcnt(6)
    buffer_store_dwordx4 v[28:31], v3, s[12:15], s10 offen offset:3072 sc1
    s_waitcnt lgkmcnt(5)
    buffer_store_dwordx4 v[32:35], v3, s[12:15], s11 offen offset:0 sc1
    s_waitcnt lgkmcnt(4)
    buffer_store_dwordx4 v[36:39], v3, s[12:15], s11 offen offset:1024 sc1
    s_waitcnt lgkmcnt(3)
    buffer_store_dwordx4 v[40:43], v3, s[12:15], s11 offen offset:2048 sc1
    s_waitcnt lgkmcnt(2)
    buffer_store_dwordx4 v[44:47], v3, s[12:15], s11 offen offset:3072 sc1
    s_waitcnt lgkmcnt(1)
    buffer_store_dwordx4 v[48:51], v3, s[12:15], s29 offen offset:0 sc1
    s_waitcnt lgkmcnt(0)
    buffer_store_dwordx4 v[52:55], v3, s[12:15], s29 offen offset:1024 sc1
P1_SIGNAL:
    v_mov_b32 v4, 163584
    ds_read_b64 v[6:7], v4
    s_waitcnt lgkmcnt(0)
    v_readfirstlane_b32 s56, v6
    v_readfirstlane_b32 s57, v7
    v_mov_b32 v4, 163600
    v_mov_b32 v5, 1
    s_waitcnt vmcnt(0)
    s_mov_b64 exec, 1
    ds_add_rtn_u32 v6, v4, v5
    s_waitcnt lgkmcnt(0)
    v_readfirstlane_b32 s10, v6
    s_mov_b64 exec, -1
    s_cmp_lg_u32 s10, 3
    s_cbranch_scc1 P1_NOSIG
    s_lshl_b32 s58, s55, 6
    s_add_u32 s58, s58, 0x1210000
    v_mov_b32 v4, s58
    v_mov_b32 v6, s56
    v_mov_b32 v7, s57
    s_mov_b64 exec, 1
    buffer_store_dwordx2 v[6:7], v4, s[12:15], 0 offen sc0 sc1
    s_mov_b64 exec, -1
P1_NOSIG:
    s_cmp_eq_u32 s51, 0
    s_cbranch_scc1 P2_COMMON
P15_CONV:
    s_waitcnt vmcnt(0)
    s_lshr_b32 s17, s50, 1
    s_lshl_b32 s17, s17, 2
    s_load_dword s54, s[72:73], s17
    s_cmp_eq_u32 s51, 1
    s_movk_i32 s17, 2560
    s_cselect_b32 s17, 5120, s17
    s_movk_i32 s53, 2112
    s_cselect_b32 s53, 4160, s53
    s_add_u32 s17, s17, s16
    s_add_u32 s52, s17, 2480
    v_and_b32 v2, 31, v1
    v_lshrrev_b32 v3, 5, v1
    v_lshlrev_b32 v9, 4, v1
    v_add_u32 v10, s17, v9
    v_add_u32 v20, s52, v9
    v_add_u32 v21, s53, v20
    v_add_u32 v22, s53, v21
    v_add_u32 v23, s53, v22
    v_mov_b32 v12, 0
    v_mov_b32 v13, 0
    v_mov_b32 v14, 0
    v_mov_b32 v15, 0
    ds_write_b128 v10, v[12:15]
    ds_write_b128 v10, v[12:15] offset:1024
    s_mov_b32 exec_hi, 0
    s_mov_b32 exec_lo, 0x7ffffff
    ds_write_b128 v10, v[12:15] offset:2048
    s_mov_b64 exec, -1
    v_readfirstlane_b32 s17, v124
    v_readfirstlane_b32 s18, v125
    v_cmp_eq_u32 vcc, 3, v1
    v_mov_b32 v16, s17
    v_mov_b32 v17, s18
    v_cndmask_b32 v16, 0, v16, vcc
    v_cndmask_b32 v17, 0, v17, vcc
    s_mov_b64 exec, 15
    v_alignbit_b32 v64, v13, v12, 16
    v_mov_b32 v68, v13
    v_alignbit_b32 v72, v14, v13, 16
    v_mov_b32 v76, v14
    v_alignbit_b32 v65, v14, v13, 16
    v_mov_b32 v69, v14
    v_alignbit_b32 v73, v15, v14, 16
    v_mov_b32 v77, v15
    v_alignbit_b32 v66, v15, v14, 16
    v_mov_b32 v70, v15
    v_alignbit_b32 v74, v16, v15, 16
    v_mov_b32 v78, v16
    v_alignbit_b32 v67, v16, v15, 16
    v_mov_b32 v71, v16
    v_alignbit_b32 v75, v17, v16, 16
    v_mov_b32 v79, v17
    ds_write_b128 v20, v[64:67] offset:0
    ds_write_b128 v21, v[68:71] offset:0
    ds_write_b128 v22, v[72:75] offset:0
    ds_write_b128 v23, v[76:79] offset:0
    s_mov_b64 exec, -1
    v_alignbit_b32 v64, v125, v124, 16
    v_mov_b32 v68, v125
    v_alignbit_b32 v72, v126, v125, 16
    v_mov_b32 v76, v126
    v_alignbit_b32 v65, v126, v125, 16
    v_mov_b32 v69, v126
    v_alignbit_b32 v73, v127, v126, 16
    v_mov_b32 v77, v127
    v_alignbit_b32 v66, v127, v126, 16
    v_mov_b32 v70, v127
    v_alignbit_b32 v74, v140, v127, 16
    v_mov_b32 v78, v140
    v_alignbit_b32 v67, v140, v127, 16
    v_mov_b32 v71, v140
    v_alignbit_b32 v75, v141, v140, 16
    v_mov_b32 v79, v141
    ds_write_b128 v20, v[64:67] offset:64
    ds_write_b128 v21, v[68:71] offset:64
    ds_write_b128 v22, v[72:75] offset:64
    ds_write_b128 v23, v[76:79] offset:64
    v_alignbit_b32 v64, v129, v128, 16
    v_mov_b32 v68, v129
    v_alignbit_b32 v72, v130, v129, 16
    v_mov_b32 v76, v130
    v_alignbit_b32 v65, v130, v129, 16
    v_mov_b32 v69, v130
    v_alignbit_b32 v73, v131, v130, 16
    v_mov_b32 v77, v131
    v_alignbit_b32 v66, v131, v130, 16
    v_mov_b32 v70, v131
    v_alignbit_b32 v74, v142, v131, 16
    v_mov_b32 v78, v142
    v_alignbit_b32 v67, v142, v131, 16
    v_mov_b32 v71, v142
    v_alignbit_b32 v75, v143, v142, 16
    v_mov_b32 v79, v143
    ds_write_b128 v20, v[64:67] offset:1088
    ds_write_b128 v21, v[68:71] offset:1088
    ds_write_b128 v22, v[72:75] offset:1088
    ds_write_b128 v23, v[76:79] offset:1088
    s_cmp_eq_u32 s51, 2
    s_cbranch_scc1 CVB_26
    v_alignbit_b32 v64, v133, v132, 16
    v_mov_b32 v68, v133
    v_alignbit_b32 v72, v134, v133, 16
    v_mov_b32 v76, v134
    v_alignbit_b32 v65, v134, v133, 16
    v_mov_b32 v69, v134
    v_alignbit_b32 v73, v135, v134, 16
    v_mov_b32 v77, v135
    v_alignbit_b32 v66, v135, v134, 16
    v_mov_b32 v70, v135
    v_alignbit_b32 v74, v144, v135, 16
    v_mov_b32 v78, v144
    v_alignbit_b32 v67, v144, v135, 16
    v_mov_b32 v71, v144
    v_alignbit_b32 v75, v145, v144, 16
    v_mov_b32 v79, v145
    ds_write_b128 v20, v[64:67] offset:2112
    ds_write_b128 v21, v[68:71] offset:2112
    ds_write_b128 v22, v[72:75] offset:2112
    ds_write_b128 v23, v[76:79] offset:2112
    v_alignbit_b32 v64, v137, v136, 16
    v_mov_b32 v68, v137
    v_alignbit_b32 v72, v138, v137, 16
    v_mov_b32 v76, v138
    v_alignbit_b32 v65, v138, v137, 16
    v_mov_b32 v69, v138
    v_alignbit_b32 v73, v139, v138, 16
    v_mov_b32 v77, v139
    v_alignbit_b32 v66, v139, v138, 16
    v_mov_b32 v70, v139
    v_alignbit_b32 v74, v146, v139, 16
    v_mov_b32 v78, v146
    v_alignbit_b32 v67, v146, v139, 16
    v_mov_b32 v71, v146
    v_alignbit_b32 v75, v147, v146, 16
    v_mov_b32 v79, v147
    ds_write_b128 v20, v[64:67] offset:3136
    ds_write_b128 v21, v[68:71] offset:3136
    ds_write_b128 v22, v[72:75] offset:3136
    ds_write_b128 v23, v[76:79] offset:3136
CVB_26:
    v_and_b32 v11, 3, v2
    v_mul_lo_u32 v11, v11, s53
    v_lshrrev_b32 v10, 2, v2
    v_lshl_add_u32 v10, v10, 3, v11
    v_lshl_add_u32 v10, v3, 4, v10
    v_add_u32 v4, s52, v10
    s_cmp_eq_u32 s51, 1
    s_cselect_b32 s53, 8, 4
    v_sub_u32 v10, 31, v2
    v_mul_u32_u24 v10, 80, v10
    v_add_u32 v10, s16, v10
    v_lshl_add_u32 v5, v3, 4, v10
    v_lshlrev_b32 v11, 3, v3
    v_sub_u32 v10, v10, v11
    v_add_u32 v6, 8, v10
    v_mov_b32 v32, 0
    v_mov_b32 v33, 0
    v_mov_b32 v34, 0
    v_mov_b32 v35, 0
    v_mov_b32 v36, 0
    v_mov_b32 v37, 0
    v_mov_b32 v38, 0
    v_mov_b32 v39, 0
    v_mov_b32 v40, 0
    v_mov_b32 v41, 0
    v_mov_b32 v42, 0
    v_mov_b32 v43, 0
    v_mov_b32 v44, 0
    v_mov_b32 v45, 0
    v_mov_b32 v46, 0
    v_mov_b32 v47, 0
    s_lshl_b32 s17, s26, 2
    s_add_u32 s17, s17, 163616
    v_mov_b32 v10, s17
    s_mov_b32 s17, 0
LW_27:
    ds_read_b32 v11, v10
    s_waitcnt lgkmcnt(0)
    v_readfirstlane_b32 s18, v11
    s_add_u32 s17, s17, 1
    s_cmp_gt_u32 s17, 240000
    s_cbranch_scc1 LWD_28
    s_cmp_lt_u32 s18, 1
    s_cbranch_scc1 LW_27
LWD_28:
    ds_read_b64 v[96:97], v4 offset:0
    ds_read_b64 v[98:99], v4 offset:8
    ds_read_b128 v[100:103], v5 offset:0
    ds_read_b64 v[104:105], v4 offset:32
    ds_read_b64 v[106:107], v4 offset:40
    ds_read_b128 v[108:111], v5 offset:32
    ds_read_b64 v[112:113], v4 offset:64
    ds_read_b64 v[114:115], v4 offset:72
    ds_read_b128 v[116:119], v5 offset:80
CV_SEG:
    ds_read_b64 v[48:49], v4 offset:96
    ds_read_b64 v[50:51], v4 offset:104
    ds_read_b128 v[52:55], v5 offset:112
    s_waitcnt lgkmcnt(9)
    v_mfma_f32_32x32x16_bf16 v[32:47], v[96:99], v[100:103], v[32:47]
    ds_read_b64 v[96:97], v4 offset:128
    ds_read_b64 v[98:99], v4 offset:136
    ds_read_b128 v[100:103], v5 offset:160
    s_waitcnt lgkmcnt(9)
    v_mfma_f32_32x32x16_bf16 v[32:47], v[104:107], v[108:111], v[32:47]
    ds_read_b64 v[104:105], v4 offset:160
    ds_read_b64 v[106:107], v4 offset:168
    ds_read_b128 v[108:111], v5 offset:192
    s_waitcnt lgkmcnt(9)
    v_mfma_f32_32x32x16_bf16 v[32:47], v[112:115], v[116:119], v[32:47]
    ds_read_b64 v[112:113], v4 offset:192
    ds_read_b64 v[114:115], v4 offset:200
    ds_read_b128 v[116:119], v5 offset:240
    s_waitcnt lgkmcnt(9)
    v_mfma_f32_32x32x16_bf16 v[32:47], v[48:51], v[52:55], v[32:47]
    ds_read_b64 v[48:49], v4 offset:224
    ds_read_b64 v[50:51], v4 offset:232
    ds_read_b128 v[52:55], v5 offset:272
    s_waitcnt lgkmcnt(9)
    v_mfma_f32_32x32x16_bf16 v[32:47], v[96:99], v[100:103], v[32:47]
    ds_read_b64 v[96:97], v4 offset:256
    ds_read_b64 v[98:99], v4 offset:264
    ds_read_b128 v[100:103], v5 offset:320
    s_waitcnt lgkmcnt(9)
    v_mfma_f32_32x32x16_bf16 v[32:47], v[104:107], v[108:111], v[32:47]
    ds_read_b64 v[104:105], v4 offset:288
    ds_read_b64 v[106:107], v4 offset:296
    ds_read_b128 v[108:111], v5 offset:352
    s_waitcnt lgkmcnt(9)
    v_mfma_f32_32x32x16_bf16 v[32:47], v[112:115], v[116:119], v[32:47]
    ds_read_b64 v[112:113], v4 offset:320
    ds_read_b64 v[114:115], v4 offset:328
    ds_read_b128 v[116:119], v5 offset:400
    s_waitcnt lgkmcnt(9)
    v_mfma_f32_32x32x16_bf16 v[32:47], v[48:51], v[52:55], v[32:47]
    ds_read_b64 v[48:49], v4 offset:352
    ds_read_b64 v[50:51], v4 offset:360
    ds_read_b128 v[52:55], v5 offset:432
    s_waitcnt lgkmcnt(9)
    v_mfma_f32_32x32x16_bf16 v[32:47], v[96:99], v[100:103], v[32:47]
    ds_read_b64 v[96:97], v4 offset:384
    ds_read_b64 v[98:99], v4 offset:392
    ds_read_b128 v[100:103], v5 offset:480
    s_waitcnt lgkmcnt(9)
    v_mfma_f32_32x32x16_bf16 v[32:47], v[104:107], v[108:111], v[32:47]
    ds_read_b64 v[104:105], v4 offset:416
    ds_read_b64 v[106:107], v4 offset:424
    ds_read_b128 v[108:111], v5 offset:512
    s_waitcnt lgkmcnt(9)
    v_mfma_f32_32x32x16_bf16 v[32:47], v[112:115], v[116:119], v[32:47]
    ds_read_b64 v[112:113], v4 offset:448
    ds_read_b64 v[114:115], v4 offset:456
    ds_read_b128 v[116:119], v5 offset:560
    s_waitcnt lgkmcnt(9)
    v_mfma_f32_32x32x16_bf16 v[32:47], v[48:51], v[52:55], v[32:47]
    ds_read_b64 v[48:49], v4 offset:480
    ds_read_b64 v[50:51], v4 offset:488
    ds_read_b128 v[52:55], v5 offset:592
    s_waitcnt lgkmcnt(9)
    v_mfma_f32_32x32x16_bf16 v[32:47], v[96:99], v[100:103], v[32:47]
    ds_read_b64 v[96:97], v4 offset:512
    ds_read_b64 v[98:99], v4 offset:520
    ds_read_b128 v[100:103], v5 offset:640
    s_waitcnt lgkmcnt(9)
    v_mfma_f32_32x32x16_bf16 v[32:47], v[104:107], v[108:111], v[32:47]
    ds_read_b64 v[104:105], v4 offset:544
    ds_read_b64 v[106:107], v4 offset:552
    ds_read_b128 v[108:111], v5 offset:672
    s_waitcnt lgkmcnt(9)
    v_mfma_f32_32x32x16_bf16 v[32:47], v[112:115], v[116:119], v[32:47]
    ds_read_b64 v[112:113], v4 offset:576
    ds_read_b64 v[114:115], v4 offset:584
    ds_read_b128 v[116:119], v5 offset:720
    s_waitcnt lgkmcnt(9)
    v_mfma_f32_32x32x16_bf16 v[32:47], v[48:51], v[52:55], v[32:47]
    v_add_u32 v5, 640, v5
    v_add_u32 v4, 512, v4
    s_sub_u32 s53, s53, 1
    s_cmp_lg_u32 s53, 0
    s_cbranch_scc1 CV_SEG
    ds_read_b64 v[64:65], v6 offset:48
    ds_read_b64 v[66:67], v6 offset:32
    ds_read_b64 v[68:69], v6 offset:16
    ds_read_b64 v[70:71], v6 offset:0
    s_and_b32 s17, s50, 1
    s_lshl_b32 s18, s54, 16
    s_and_b32 s54, s54, 0xffff0000
    s_cmp_eq_u32 s17, 0
    s_cselect_b32 s54, s18, s54
    v_lshlrev_b32 v11, 6, v2
    v_lshl_add_u32 v11, v3, 3, v11
    v_add_u32 v11, s52, v11
    v_add_u32 v10, s52, v9
    s_lshl_b32 s17, s50, 12
    s_and_b32 s18, s51, 1
    s_lshl_b32 s18, s18, 11
    s_add_u32 s17, s17, s18
    s_add_u32 s17, s17, 0xc00000
    s_mov_b32 s18, 0xffff0000
    s_waitcnt lgkmcnt(0)
    s_nop 4
    v_and_b32 v16, s18, v65
    v_lshlrev_b32 v17, 16, v65
    v_and_b32 v18, s18, v64
    v_lshlrev_b32 v19, 16, v64
    v_fmac_f32 v32, s54, v16
    v_fmac_f32 v33, s54, v17
    v_fmac_f32 v34, s54, v18
    v_fmac_f32 v35, s54, v19
    v_cvt_pk_bf16_f32 v72, v32, v33
    v_cvt_pk_bf16_f32 v73, v34, v35
    ds_write_b64 v11, v[72:73] offset:0
    v_and_b32 v16, s18, v67
    v_lshlrev_b32 v17, 16, v67
    v_and_b32 v18, s18, v66
    v_lshlrev_b32 v19, 16, v66
    v_fmac_f32 v36, s54, v16
    v_fmac_f32 v37, s54, v17
    v_fmac_f32 v38, s54, v18
    v_fmac_f32 v39, s54, v19
    v_cvt_pk_bf16_f32 v74, v36, v37
    v_cvt_pk_bf16_f32 v75, v38, v39
    ds_write_b64 v11, v[74:75] offset:16
    v_and_b32 v16, s18, v69
    v_lshlrev_b32 v17, 16, v69
    v_and_b32 v18, s18, v68
    v_lshlrev_b32 v19, 16, v68
    v_fmac_f32 v40, s54, v16
    v_fmac_f32 v41, s54, v17
    v_fmac_f32 v42, s54, v18
    v_fmac_f32 v43, s54, v19
    v_cvt_pk_bf16_f32 v76, v40, v41
    v_cvt_pk_bf16_f32 v77, v42, v43
    ds_write_b64 v11, v[76:77] offset:32
    v_and_b32 v16, s18, v71
    v_lshlrev_b32 v17, 16, v71
    v_and_b32 v18, s18, v70
    v_lshlrev_b32 v19, 16, v70
    v_fmac_f32 v44, s54, v16
    v_fmac_f32 v45, s54, v17
    v_fmac_f32 v46, s54, v18
    v_fmac_f32 v47, s54, v19
    v_cvt_pk_bf16_f32 v78, v44, v45
    v_cvt_pk_bf16_f32 v79, v46, v47
    ds_write_b64 v11, v[78:79] offset:48
    ds_read_b128 v[152:155], v10
    ds_read_b128 v[156:159], v10 offset:1024
    v_mov_b32 v151, v9
    s_mov_b32 s39, s17
    v_mov_b32 v16, 163584
    ds_read_b64 v[18:19], v16
    s_waitcnt lgkmcnt(0)
    v_readfirstlane_b32 s56, v18
    v_readfirstlane_b32 s57, v19
P2_COMMON:
    v_and_b32 v2, 31, v1
    v_lshrrev_b32 v3, 5, v1
    s_and_b32 s24, s2, 7
    s_lshl_b32 s24, s24, 2
    s_lshr_b32 s10, s2, 3
    s_and_b32 s10, s10, 3
    s_add_u32 s24, s24, s10
    s_lshr_b32 s25, s2, 5
    s_mul_i32 s27, s24, 196608
    s_add_u32 s27, s27, 0x300000
    s_cmp_ge_u32 s26, 8
    s_cbranch_scc1 P2_HELP
    v_and_b32 v14, 0x13, v2
    v_and_b32 v15, 4, v2
    v_lshl_or_b32 v14, v15, 1, v14
    v_and_b32 v15, 8, v2
    v_lshrrev_b32 v15, 1, v15
    v_or_b32 v14, v14, v15
    v_mul_u32_u24 v14, 48, v14
    v_add_u32 v112, 32, v14
    v_lshl_add_u32 v113, v3, 4, v14
    v_min_u32 v14, 21, v2
    v_lshlrev_b32 v14, 4, v14
    v_mul_u32_u24 v15, 352, v3
    v_add_u32 v114, v14, v15
    v_add_u32 v114, 12288, v114
    v_mov_b32 v5, v113
    v_mov_b32 v6, v112
    v_mov_b32 v7, v114
    s_lshl_b32 s10, s26, 5
    v_add_u32 v14, s10, v2
    v_mul_u32_u24 v14, 48, v14
    v_add_u32 v14, 150896, v14
    v_lshl_add_u32 v15, v3, 4, v14
    v_mov_b32 v80, 0
    v_mov_b32 v81, 0
    v_mov_b32 v82, 0
    v_mov_b32 v83, 0
    v_mov_b32 v84, 0
    v_mov_b32 v85, 0
    v_mov_b32 v86, 0
    v_mov_b32 v87, 0
    v_mov_b32 v88, 0
    v_mov_b32 v89, 0
    v_mov_b32 v90, 0
    v_mov_b32 v91, 0
    v_mov_b32 v92, 0
    v_mov_b32 v93, 0
    v_mov_b32 v94, 0
    v_mov_b32 v95, 0
    v_mov_b32 v44, 0
    v_mov_b32 v36, 0
    v_mov_b32 v45, 0
    v_mov_b32 v37, 0
    v_mov_b32 v46, 0
    v_mov_b32 v38, 0
    v_mov_b32 v47, 0
    v_mov_b32 v39, 0
    v_cmp_eq_u32 vcc, 0, v3
    s_waitcnt lgkmcnt(0)
    s_barrier
    ds_read_b128 v[8:11], v15
    ds_read_b64 v[12:13], v14 offset:32
    ds_read_b128 v[16:19], v5 offset:0
    ds_read_b64 v[20:21], v6 offset:0
    ds_read_b128 v[24:27], v5 offset:1536
    ds_read_b64 v[28:29], v6 offset:1536
    ds_read_b128 v[32:35], v7
    s_waitcnt lgkmcnt(3)
    v_cndmask_b32 v12, 0, v12, vcc
    v_cndmask_b32 v13, 0, v13, vcc
    v_mfma_f32_32x32x16_bf16 v[48:63], v[16:19], v[8:11], 0
    s_nop 0
    v_mfma_f32_32x32x8_bf16 v[48:63], v[20:21], v[12:13], v[48:63]
    s_nop 15
    s_nop 3
    v_max3_f32 v14, v48, v49, v50
    v_max3_f32 v14, v14, v51, v52
    v_max3_f32 v14, v14, v53, v54
    v_max3_f32 v14, v14, v55, v56
    v_max3_f32 v14, v14, v57, v58
    v_max3_f32 v14, v14, v59, v60
    v_max3_f32 v14, v14, v61, v62
    v_max_f32 v14, v14, v63
    v_mov_b32 v15, v14
    s_nop 1
    v_permlane32_swap_b32 v14, v15
    s_nop 1
    v_max_f32 v14, v14, v15
    v_sub_f32 v96, 0, v14
    v_sub_f32 v97, 0, v14
    v_sub_f32 v98, 0, v14
    v_sub_f32 v99, 0, v14
    v_sub_f32 v100, 0, v14
    v_sub_f32 v101, 0, v14
    v_sub_f32 v102, 0, v14
    v_sub_f32 v103, 0, v14
    v_sub_f32 v104, 0, v14
    v_sub_f32 v105, 0, v14
    v_sub_f32 v106, 0, v14
    v_sub_f32 v107, 0, v14
    v_sub_f32 v108, 0, v14
    v_sub_f32 v109, 0, v14
    v_sub_f32 v110, 0, v14
    v_sub_f32 v111, 0, v14
    v_sub_f32 v48, v48, v14
    v_sub_f32 v49, v49, v14
    v_sub_f32 v50, v50, v14
    v_sub_f32 v51, v51, v14
    v_sub_f32 v52, v52, v14
    v_sub_f32 v53, v53, v14
    v_sub_f32 v54, v54, v14
    v_sub_f32 v55, v55, v14
    v_sub_f32 v56, v56, v14
    v_sub_f32 v57, v57, v14
    v_sub_f32 v58, v58, v14
    v_sub_f32 v59, v59, v14
    v_sub_f32 v60, v60, v14
    v_sub_f32 v61, v61, v14
    v_sub_f32 v62, v62, v14
    v_sub_f32 v63, v63, v14
    s_cmp_eq_u32 s51, 0
    s_cbranch_scc1 P2_NOZ
    buffer_store_dwordx4 v[152:155], v151, s[12:15], s39 offen sc1
    buffer_store_dwordx4 v[156:159], v151, s[12:15], s39 offen offset:1024 sc1
P2_NOZ:
    s_mov_b32 s30, 0
    s_mov_b32 s32, 24576
    s_mov_b32 s33, 0
.p2align 6
P2_LOOP:
    s_waitcnt lgkmcnt(1)
    v_mfma_f32_32x32x16_bf16 v[64:79], v[24:27], v[8:11], v[96:111]
    v_exp_f32 v48, v48
    v_exp_f32 v49, v49
    v_exp_f32 v50, v50
    v_exp_f32 v51, v51
    v_cvt_pk_bf16_f32 v40, v48, v49
    v_mfma_f32_32x32x16_bf16 v[80:95], v[36:39], v[44:47], v[80:95]
    ds_read_b128 v[36:39], v7 offset:704
    v_exp_f32 v52, v52
    v_cvt_pk_bf16_f32 v41, v50, v51
    v_exp_f32 v53, v53
    v_exp_f32 v54, v54
    v_exp_f32 v55, v55
    v_cvt_pk_bf16_f32 v42, v52, v53
    v_mfma_f32_32x32x8_bf16 v[64:79], v[28:29], v[12:13], v[64:79]
    ds_read_b128 v[16:19], v5 offset:3072
    ds_read_b64 v[20:21], v6 offset:3072
    v_exp_f32 v56, v56
    v_cvt_pk_bf16_f32 v43, v54, v55
    v_exp_f32 v57, v57
    v_exp_f32 v58, v58
    v_exp_f32 v59, v59
    v_cvt_pk_bf16_f32 v44, v56, v57
    s_waitcnt lgkmcnt(3)
    v_mfma_f32_32x32x16_bf16 v[80:95], v[32:35], v[40:43], v[80:95]
    ds_read_b128 v[32:35], v7 offset:1408
    v_exp_f32 v60, v60
    v_cvt_pk_bf16_f32 v45, v58, v59
    v_exp_f32 v61, v61
    v_exp_f32 v62, v62
    v_exp_f32 v63, v63
    v_cvt_pk_bf16_f32 v46, v60, v61
    v_cvt_pk_bf16_f32 v47, v62, v63
    s_waitcnt lgkmcnt(1)
    v_mfma_f32_32x32x16_bf16 v[48:63], v[16:19], v[8:11], v[96:111]
    v_exp_f32 v64, v64
    v_exp_f32 v65, v65
    v_exp_f32 v66, v66
    v_exp_f32 v67, v67
    v_cvt_pk_bf16_f32 v40, v64, v65
    v_mfma_f32_32x32x16_bf16 v[80:95], v[36:39], v[44:47], v[80:95]
    ds_read_b128 v[36:39], v7 offset:2112
    v_exp_f32 v68, v68
    v_cvt_pk_bf16_f32 v41, v66, v67
    v_exp_f32 v69, v69
    v_exp_f32 v70, v70
    v_exp_f32 v71, v71
    v_cvt_pk_bf16_f32 v42, v68, v69
    v_mfma_f32_32x32x8_bf16 v[48:63], v[20:21], v[12:13], v[48:63]
    ds_read_b128 v[24:27], v5 offset:4608
    ds_read_b64 v[28:29], v6 offset:4608
    v_exp_f32 v72, v72
    v_cvt_pk_bf16_f32 v43, v70, v71
    v_exp_f32 v73, v73
    v_exp_f32 v74, v74
    v_exp_f32 v75, v75
    v_cvt_pk_bf16_f32 v44, v72, v73
    s_waitcnt lgkmcnt(3)
    v_mfma_f32_32x32x16_bf16 v[80:95], v[32:35], v[40:43], v[80:95]
    ds_read_b128 v[32:35], v7 offset:2816
    v_exp_f32 v76, v76
    v_cvt_pk_bf16_f32 v45, v74, v75
    v_exp_f32 v77, v77
    v_exp_f32 v78, v78
    v_exp_f32 v79, v79
    v_cvt_pk_bf16_f32 v46, v76, v77
    v_cvt_pk_bf16_f32 v47, v78, v79
    s_waitcnt lgkmcnt(1)
    v_mfma_f32_32x32x16_bf16 v[64:79], v[24:27], v[8:11], v[96:111]
    v_exp_f32 v48, v48
    v_exp_f32 v49, v49
    v_exp_f32 v50, v50
    v_exp_f32 v51, v51
    v_cvt_pk_bf16_f32 v40, v48, v49
    v_mfma_f32_32x32x16_bf16 v[80:95], v[36:39], v[44:47], v[80:95]
    ds_read_b128 v[36:39], v7 offset:3520
    v_exp_f32 v52, v52
    v_cvt_pk_bf16_f32 v41, v50, v51
    v_exp_f32 v53, v53
    v_exp_f32 v54, v54
    v_exp_f32 v55, v55
    v_cvt_pk_bf16_f32 v42, v52, v53
    v_mfma_f32_32x32x8_bf16 v[64:79], v[28:29], v[12:13], v[64:79]
    ds_read_b128 v[16:19], v5 offset:6144
    ds_read_b64 v[20:21], v6 offset:6144
    v_exp_f32 v56, v56
    v_cvt_pk_bf16_f32 v43, v54, v55
    v_exp_f32 v57, v57
    v_exp_f32 v58, v58
    v_exp_f32 v59, v59
    v_cvt_pk_bf16_f32 v44, v56, v57
    s_waitcnt lgkmcnt(3)
    v_mfma_f32_32x32x16_bf16 v[80:95], v[32:35], v[40:43], v[80:95]
    ds_read_b128 v[32:35], v7 offset:4224
    v_exp_f32 v60, v60
    v_cvt_pk_bf16_f32 v45, v58, v59
    v_exp_f32 v61, v61
    v_exp_f32 v62, v62
    v_exp_f32 v63, v63
    v_cvt_pk_bf16_f32 v46, v60, v61
    v_cvt_pk_bf16_f32 v47, v62, v63
    s_waitcnt lgkmcnt(1)
    v_mfma_f32_32x32x16_bf16 v[48:63], v[16:19], v[8:11], v[96:111]
    v_exp_f32 v64, v64
    v_exp_f32 v65, v65
    v_exp_f32 v66, v66
    v_exp_f32 v67, v67
    v_cvt_pk_bf16_f32 v40, v64, v65
    v_mfma_f32_32x32x16_bf16 v[80:95], v[36:39], v[44:47], v[80:95]
    ds_read_b128 v[36:39], v7 offset:4928
    v_exp_f32 v68, v68
    v_cvt_pk_bf16_f32 v41, v66, v67
    v_exp_f32 v69, v69
    v_exp_f32 v70, v70
    v_exp_f32 v71, v71
    v_cvt_pk_bf16_f32 v42, v68, v69
    v_mfma_f32_32x32x8_bf16 v[48:63], v[20:21], v[12:13], v[48:63]
    ds_read_b128 v[24:27], v5 offset:7680
    ds_read_b64 v[28:29], v6 offset:7680
    v_exp_f32 v72, v72
    v_cvt_pk_bf16_f32 v43, v70, v71
    v_exp_f32 v73, v73
    v_exp_f32 v74, v74
    v_exp_f32 v75, v75
    v_cvt_pk_bf16_f32 v44, v72, v73
    s_waitcnt lgkmcnt(3)
    v_mfma_f32_32x32x16_bf16 v[80:95], v[32:35], v[40:43], v[80:95]
    ds_read_b128 v[32:35], v7 offset:5632
    v_exp_f32 v76, v76
    v_cvt_pk_bf16_f32 v45, v74, v75
    v_exp_f32 v77, v77
    v_exp_f32 v78, v78
    v_exp_f32 v79, v79
    v_cvt_pk_bf16_f32 v46, v76, v77
    v_cvt_pk_bf16_f32 v47, v78, v79
    s_waitcnt lgkmcnt(1)
    v_mfma_f32_32x32x16_bf16 v[64:79], v[24:27], v[8:11], v[96:111]
    v_exp_f32 v48, v48
    v_exp_f32 v49, v49
    v_exp_f32 v50, v50
    v_exp_f32 v51, v51
    v_cvt_pk_bf16_f32 v40, v48, v49
    v_mfma_f32_32x32x16_bf16 v[80:95], v[36:39], v[44:47], v[80:95]
    ds_read_b128 v[36:39], v7 offset:6336
    v_exp_f32 v52, v52
    v_cvt_pk_bf16_f32 v41, v50, v51
    v_exp_f32 v53, v53
    v_exp_f32 v54, v54
    v_exp_f32 v55, v55
    v_cvt_pk_bf16_f32 v42, v52, v53
    v_mfma_f32_32x32x8_bf16 v[64:79], v[28:29], v[12:13], v[64:79]
    ds_read_b128 v[16:19], v5 offset:9216
    ds_read_b64 v[20:21], v6 offset:9216
    v_exp_f32 v56, v56
    v_cvt_pk_bf16_f32 v43, v54, v55
    v_exp_f32 v57, v57
    v_exp_f32 v58, v58
    v_exp_f32 v59, v59
    v_cvt_pk_bf16_f32 v44, v56, v57
    s_waitcnt lgkmcnt(3)
    v_mfma_f32_32x32x16_bf16 v[80:95], v[32:35], v[40:43], v[80:95]
    ds_read_b128 v[32:35], v7 offset:7040
    v_exp_f32 v60, v60
    v_cvt_pk_bf16_f32 v45, v58, v59
    v_exp_f32 v61, v61
    v_exp_f32 v62, v62
    v_exp_f32 v63, v63
    v_cvt_pk_bf16_f32 v46, v60, v61
    v_cvt_pk_bf16_f32 v47, v62, v63
    s_waitcnt lgkmcnt(1)
    v_mfma_f32_32x32x16_bf16 v[48:63], v[16:19], v[8:11], v[96:111]
    v_exp_f32 v64, v64
    v_exp_f32 v65, v65
    v_exp_f32 v66, v66
    v_exp_f32 v67, v67
    v_cvt_pk_bf16_f32 v40, v64, v65
    v_mfma_f32_32x32x16_bf16 v[80:95], v[36:39], v[44:47], v[80:95]
    ds_read_b128 v[36:39], v7 offset:7744
    v_exp_f32 v68, v68
    v_cvt_pk_bf16_f32 v41, v66, v67
    v_exp_f32 v69, v69
    v_exp_f32 v70, v70
    v_exp_f32 v71, v71
    v_cvt_pk_bf16_f32 v42, v68, v69
    v_mfma_f32_32x32x8_bf16 v[48:63], v[20:21], v[12:13], v[48:63]
    ds_read_b128 v[24:27], v5 offset:10752
    ds_read_b64 v[28:29], v6 offset:10752
    v_exp_f32 v72, v72
    v_cvt_pk_bf16_f32 v43, v70, v71
    v_exp_f32 v73, v73
    v_exp_f32 v74, v74
    s_waitcnt vmcnt(0)
    s_barrier
    v_exp_f32 v75, v75
    v_cvt_pk_bf16_f32 v44, v72, v73
    s_waitcnt lgkmcnt(3)
    v_mfma_f32_32x32x16_bf16 v[80:95], v[32:35], v[40:43], v[80:95]
    ds_read_b128 v[32:35], v7 offset:8448
    v_exp_f32 v76, v76
    v_cvt_pk_bf16_f32 v45, v74, v75
    v_exp_f32 v77, v77
    v_exp_f32 v78, v78
    v_exp_f32 v79, v79
    v_cvt_pk_bf16_f32 v46, v76, v77
    v_cvt_pk_bf16_f32 v47, v78, v79
    s_waitcnt lgkmcnt(1)
    v_mfma_f32_32x32x16_bf16 v[64:79], v[24:27], v[8:11], v[96:111]
    v_exp_f32 v48, v48
    v_exp_f32 v49, v49
    v_exp_f32 v50, v50
    v_exp_f32 v51, v51
    v_cvt_pk_bf16_f32 v40, v48, v49
    v_mfma_f32_32x32x16_bf16 v[80:95], v[36:39], v[44:47], v[80:95]
    ds_read_b128 v[36:39], v7 offset:9152
    v_exp_f32 v52, v52
    v_cvt_pk_bf16_f32 v41, v50, v51
    v_exp_f32 v53, v53
    v_exp_f32 v54, v54
    v_exp_f32 v55, v55
    v_cvt_pk_bf16_f32 v42, v52, v53
    v_mfma_f32_32x32x8_bf16 v[64:79], v[28:29], v[12:13], v[64:79]
    v_add_u32 v5, s32, v5
    v_add_u32 v6, s32, v6
    ds_read_b128 v[16:19], v5 offset:0
    ds_read_b64 v[20:21], v6 offset:0
    v_exp_f32 v56, v56
    v_cvt_pk_bf16_f32 v43, v54, v55
    v_exp_f32 v57, v57
    v_exp_f32 v58, v58
    v_exp_f32 v59, v59
    v_cvt_pk_bf16_f32 v44, v56, v57
    s_waitcnt lgkmcnt(3)
    v_mfma_f32_32x32x16_bf16 v[80:95], v[32:35], v[40:43], v[80:95]
    ds_read_b128 v[32:35], v7 offset:9856
    v_exp_f32 v60, v60
    v_cvt_pk_bf16_f32 v45, v58, v59
    v_exp_f32 v61, v61
    v_exp_f32 v62, v62
    v_exp_f32 v63, v63
    v_cvt_pk_bf16_f32 v46, v60, v61
    v_cvt_pk_bf16_f32 v47, v62, v63
    s_waitcnt lgkmcnt(1)
    v_mfma_f32_32x32x16_bf16 v[48:63], v[16:19], v[8:11], v[96:111]
    v_exp_f32 v64, v64
    v_exp_f32 v65, v65
    v_exp_f32 v66, v66
    v_exp_f32 v67, v67
    v_cvt_pk_bf16_f32 v40, v64, v65
    v_mfma_f32_32x32x16_bf16 v[80:95], v[36:39], v[44:47], v[80:95]
    ds_read_b128 v[36:39], v7 offset:10560
    v_exp_f32 v68, v68
    v_cvt_pk_bf16_f32 v41, v66, v67
    v_exp_f32 v69, v69
    v_exp_f32 v70, v70
    v_exp_f32 v71, v71
    v_cvt_pk_bf16_f32 v42, v68, v69
    v_mfma_f32_32x32x8_bf16 v[48:63], v[20:21], v[12:13], v[48:63]
    ds_read_b128 v[24:27], v5 offset:1536
    ds_read_b64 v[28:29], v6 offset:1536
    v_exp_f32 v72, v72
    v_cvt_pk_bf16_f32 v43, v70, v71
    v_exp_f32 v73, v73
    v_exp_f32 v74, v74
    v_exp_f32 v75, v75
    v_cvt_pk_bf16_f32 v44, v72, v73
    s_waitcnt lgkmcnt(3)
    v_mfma_f32_32x32x16_bf16 v[80:95], v[32:35], v[40:43], v[80:95]
    v_add_u32 v7, s32, v7
    ds_read_b128 v[32:35], v7 offset:0
    v_exp_f32 v76, v76
    v_cvt_pk_bf16_f32 v45, v74, v75
    v_exp_f32 v77, v77
    v_exp_f32 v78, v78
    v_exp_f32 v79, v79
    v_cvt_pk_bf16_f32 v46, v76, v77
    v_cvt_pk_bf16_f32 v47, v78, v79
    s_add_u32 s33, s33, 1
    s_cmp_eq_u32 s33, 3
    s_cselect_b32 s33, 0, s33
    s_cmp_eq_u32 s33, 2
    s_mov_b32 s32, 24576
    s_cselect_b32 s32, 4294918144, s32
    s_add_u32 s30, s30, 1
    s_cmp_lt_u32 s30, 8
    s_cbranch_scc1 P2_LOOP
    s_waitcnt lgkmcnt(0)
    v_mfma_f32_32x32x16_bf16 v[80:95], v[36:39], v[44:47], v[80:95]
    s_nop 15
    v_mov_b32 v14, v88
    v_mov_b32 v15, v88
    s_nop 1
    v_permlane32_swap_b32 v14, v15
    s_mov_b32 s10, 0x53800000
    s_nop 0
    v_cmp_nge_f32 vcc, s10, v15
    s_cmp_eq_u64 vcc, 0
    s_cbranch_scc1 P2_STORE
    v_mov_b32 v14, 0xff800000
    v_mov_b32 v80, 0
    v_mov_b32 v81, 0
    v_mov_b32 v82, 0
    v_mov_b32 v83, 0
    v_mov_b32 v84, 0
    v_mov_b32 v85, 0
    v_mov_b32 v86, 0
    v_mov_b32 v87, 0
    v_mov_b32 v88, 0
    v_mov_b32 v89, 0
    v_mov_b32 v90, 0
    v_mov_b32 v91, 0
    v_mov_b32 v92, 0
    v_mov_b32 v93, 0
    v_mov_b32 v94, 0
    v_mov_b32 v95, 0
    s_mov_b32 s31, 0
P2_SPASS:
    s_mov_b32 s30, 0
    s_mov_b32 s29, s27
P2_SCHUNK:
    s_mov_b32 s28, s29
    s_mov_b32 s34, s29
    s_mov_b32 s33, 0
P2_STILE:
    buffer_load_dwordx4 v[16:19], v113, s[12:15], s28 offen sc1
    buffer_load_dwordx2 v[20:21], v112, s[12:15], s28 offen sc1
    buffer_load_dwordx4 v[32:35], v114, s[12:15], s34 offen sc1
    buffer_load_dwordx4 v[36:39], v114, s[12:15], s34 offen offset:704 sc1
    s_waitcnt vmcnt(0)
    v_mfma_f32_32x32x16_bf16 v[48:63], v[16:19], v[8:11], 0
    v_mfma_f32_32x32x8_bf16 v[48:63], v[20:21], v[12:13], v[48:63]
    s_nop 15
    s_nop 3
    s_cmp_lg_u32 s31, 0
    s_cbranch_scc1 P2_SEXP
    v_max3_f32 v14, v14, v48, v49
    v_max3_f32 v14, v14, v50, v51
    v_max3_f32 v14, v14, v52, v53
    v_max3_f32 v14, v14, v54, v55
    v_max3_f32 v14, v14, v56, v57
    v_max3_f32 v14, v14, v58, v59
    v_max3_f32 v14, v14, v60, v61
    v_max3_f32 v14, v14, v62, v63
    s_branch P2_SNEXT
P2_SEXP:
    v_sub_f32 v48, v48, v14
    v_sub_f32 v49, v49, v14
    v_sub_f32 v50, v50, v14
    v_sub_f32 v51, v51, v14
    v_sub_f32 v52, v52, v14
    v_sub_f32 v53, v53, v14
    v_sub_f32 v54, v54, v14
    v_sub_f32 v55, v55, v14
    v_sub_f32 v56, v56, v14
    v_sub_f32 v57, v57, v14
    v_sub_f32 v58, v58, v14
    v_sub_f32 v59, v59, v14
    v_sub_f32 v60, v60, v14
    v_sub_f32 v61, v61, v14
    v_sub_f32 v62, v62, v14
    v_sub_f32 v63, v63, v14
    v_exp_f32 v48, v48
    v_exp_f32 v49, v49
    v_exp_f32 v50, v50
    v_exp_f32 v51, v51
    v_exp_f32 v52, v52
    v_exp_f32 v53, v53
    v_exp_f32 v54, v54
    v_exp_f32 v55, v55
    v_exp_f32 v56, v56
    v_exp_f32 v57, v57
    v_exp_f32 v58, v58
    v_exp_f32 v59, v59
    v_exp_f32 v60, v60
    v_exp_f32 v61, v61
    v_exp_f32 v62, v62
    v_exp_f32 v63, v63
    s_nop 0
    v_cvt_pk_bf16_f32 v40, v48, v49
    v_cvt_pk_bf16_f32 v41, v50, v51
    v_cvt_pk_bf16_f32 v42, v52, v53
    v_cvt_pk_bf16_f32 v43, v54, v55
    v_cvt_pk_bf16_f32 v44, v56, v57
    v_cvt_pk_bf16_f32 v45, v58, v59
    v_cvt_pk_bf16_f32 v46, v60, v61
    v_cvt_pk_bf16_f32 v47, v62, v63
    s_nop 1
    v_mfma_f32_32x32x16_bf16 v[80:95], v[32:35], v[40:43], v[80:95]
    v_mfma_f32_32x32x16_bf16 v[80:95], v[36:39], v[44:47], v[80:95]
P2_SNEXT:
    s_add_u32 s28, s28, 1536
    s_add_u32 s34, s34, 1408
    s_add_u32 s33, s33, 1
    s_cmp_lt_u32 s33, 8
    s_cbranch_scc1 P2_STILE
    s_add_u32 s29, s29, 24576
    s_add_u32 s30, s30, 1
    s_cmp_lt_u32 s30, 8
    s_cbranch_scc1 P2_SCHUNK
    s_cmp_lg_u32 s31, 0
    s_cbranch_scc1 P2_SDONE
    v_mov_b32 v15, v14
    s_nop 1
    v_permlane32_swap_b32 v14, v15
    s_nop 1
    v_max_f32 v14, v14, v15
    s_mov_b32 s31, 1
    s_branch P2_SPASS
P2_SDONE:
    s_nop 15
    v_mov_b32 v14, v88
    v_mov_b32 v15, v88
    s_nop 1
    v_permlane32_swap_b32 v14, v15
    s_nop 1
P2_STORE:
    v_rcp_f32 v15, v15
    s_lshl_b32 s10, s25, 8
    s_lshl_b32 s11, s26, 5
    s_add_u32 s10, s10, s11
    v_add_u32 v16, s10, v2
    v_lshrrev_b32 v17, 4, v16
    v_mul_u32_u24 v17, 20480, v17
    v_and_b32 v16, 15, v16
    v_lshl_add_u32 v17, v16, 4, v17
    v_add_u32 v17, 0xf00000, v17
    s_lshr_b32 s10, s24, 1
    s_mul_i32 s10, s10, 5
    s_and_b32 s11, s24, 1
    s_lshl_b32 s28, s11, 1
    s_add_u32 s28, s28, s10
    v_add_u32 v18, s28, v3
    v_lshl_add_u32 v28, v18, 8, v17
    s_add_u32 s10, s10, 4
    s_lshl_b32 s10, s10, 8
    s_lshl_b32 s11, s11, 3
    s_add_u32 s10, s10, s11
    v_add_u32 v29, s10, v17
    v_mul_f32 v80, v80, v15
    v_mul_f32 v81, v81, v15
    v_mul_f32 v82, v82, v15
    v_mul_f32 v83, v83, v15
    v_mul_f32 v84, v84, v15
    v_mul_f32 v85, v85, v15
    v_mul_f32 v86, v86, v15
    v_mul_f32 v87, v87, v15
    v_mul_f32 v88, v88, v15
    v_mul_f32 v89, v89, v15
    v_mul_f32 v90, v90, v15
    v_mul_f32 v91, v91, v15
    v_cvt_pk_bf16_f32 v20, v80, v81
    v_cvt_pk_bf16_f32 v21, v82, v83
    v_cvt_pk_bf16_f32 v22, v84, v85
    v_cvt_pk_bf16_f32 v23, v86, v87
    v_cvt_pk_bf16_f32 v24, v88, v89
    v_cvt_pk_bf16_f32 v25, v90, v91
    buffer_store_dwordx4 v[20:23], v28, s[12:15], 0 offen sc1
    s_mov_b32 exec_hi, 0
    buffer_store_dwordx2 v[24:25], v29, s[12:15], 0 offen sc1
    s_mov_b32 exec_hi, -1
    s_lshl_b32 s28, s24, 3
    s_add_u32 s28, s28, s25
    s_lshl_b32 s28, s28, 3
    s_add_u32 s28, s28, s26
    s_cmp_ge_u32 s26, 4
    s_cbranch_scc1 P2_DONE_HI
    s_mov_b32 s16, s76
    s_and_b32 s17, s77, 0xffff
    s_mov_b32 s18, 0x280000
    s_mov_b32 s19, 0x00020000
    v_lshlrev_b32 v5, 4, v1
    s_lshl_b32 s3, s24, 2
    s_add_u32 s3, s3, s26
    s_mul_i32 s32, s3, 20480
    s_add_u32 s32, s32, 0xf00000
    s_lshl_b32 s36, s3, 4
    s_mul_i32 s40, s36, 1280
    s_mul_i32 s41, s26, 2560
    s_add_u32 s41, s41, 49152
    v_and_b32 v2, 15, v1
    v_lshrrev_b32 v3, 4, v1
    v_lshrrev_b32 v6, 2, v2
    v_lshl_add_u32 v6, v3, 2, v6
    v_and_b32 v7, 3, v1
    v_lshrrev_b32 v28, 2, v2
    v_mul_u32_u24 v28, 160, v28
    v_lshl_add_u32 v28, v7, 3, v28
    v_add_u32 v28, 61184, v28
    s_mov_b32 s10, 0x18140400
    v_lshlrev_b32 v29, 3, v3
    v_lshrrev_b32 v29, v29, s10
    v_and_b32 v29, 0xff, v29
    v_mul_u32_u24 v29, 160, v29
    v_add_u32 v158, v29, v28
    s_mov_b32 s10, 0x201c0c08
    v_lshlrev_b32 v29, 3, v3
    v_lshrrev_b32 v29, v29, s10
    v_and_b32 v29, 0xff, v29
    v_mul_u32_u24 v29, 160, v29
    v_add_u32 v159, v29, v28
    s_mov_b32 s10, 0x3c2c2810
    v_lshlrev_b32 v29, 3, v3
    v_lshrrev_b32 v29, v29, s10
    v_and_b32 v29, 0xff, v29
    v_mul_u32_u24 v29, 160, v29
    v_add_u32 v160, v29, v28
    s_mov_b32 s10, 0x44343024
    v_lshlrev_b32 v29, 3, v3
    v_lshrrev_b32 v29, v29, s10
    v_and_b32 v29, 0xff, v29
    v_mul_u32_u24 v29, 160, v29
    v_add_u32 v161, v29, v28
    s_mov_b32 s10, 0x54503840
    v_lshlrev_b32 v29, 3, v3
    v_lshrrev_b32 v29, v29, s10
    v_and_b32 v29, 0xff, v29
    v_mul_u32_u24 v29, 160, v29
    v_add_u32 v162, v29, v28
    s_mov_b32 s10, 0x5c584c48
    v_lshlrev_b32 v29, 3, v3
    v_lshrrev_b32 v29, v29, s10
    v_and_b32 v29, 0xff, v29
    v_mul_u32_u24 v29, 160, v29
    v_add_u32 v163, v29, v28
    s_mov_b32 s10, 0x78606864
    v_lshlrev_b32 v29, 3, v3
    v_lshrrev_b32 v29, v29, s10
    v_and_b32 v29, 0xff, v29
    v_mul_u32_u24 v29, 160, v29
    v_add_u32 v164, v29, v28
    s_mov_b32 s10, 0x8074706c
    v_lshlrev_b32 v29, 3, v3
    v_lshrrev_b32 v29, v29, s10
    v_and_b32 v29, 0xff, v29
    v_mul_u32_u24 v29, 160, v29
    v_add_u32 v165, v29, v28
    s_mov_b32 s10, 0x88908c7c
    v_lshlrev_b32 v29, 3, v3
    v_lshrrev_b32 v29, v29, s10
    v_and_b32 v29, 0xff, v29
    v_mul_u32_u24 v29, 160, v29
    v_add_u32 v166, v29, v28
    s_mov_b32 s10, 0x9c989484
    v_lshlrev_b32 v29, 3, v3
    v_lshrrev_b32 v29, v29, s10
    v_and_b32 v29, 0xff, v29
    v_mul_u32_u24 v29, 160, v29
    v_add_u32 v167, v29, v28
    v_lshlrev_b32 v30, 7, v6
    v_lshl_add_u32 v30, v7, 3, v30
    s_lshl_b32 s37, s26, 5
    s_add_u32 s37, s37, 0
    v_add_u32 v30, s37, v30
    v_mul_u32_u24 v31, 160, v2
    v_lshl_add_u32 v31, v3, 3, v31
    v_add_u32 v31, s41, v31
    v_lshlrev_b32 v7, 2, v2
    s_lshl_b32 s36, s36, 2
    s_add_u32 s36, s36, 0x1200000
    v_mov_b32 v112, 0
    v_mov_b32 v113, 0
    v_mov_b32 v114, 0
    v_mov_b32 v115, 0
    v_mov_b32 v116, 0
    v_mov_b32 v117, 0
    v_mov_b32 v118, 0
    v_mov_b32 v119, 0
    v_mov_b32 v120, 0
    v_mov_b32 v121, 0
    v_mov_b32 v122, 0
    v_mov_b32 v123, 0
    v_mov_b32 v124, 0
    v_mov_b32 v125, 0
    v_mov_b32 v126, 0
    v_mov_b32 v127, 0
    v_mov_b32 v128, 0
    v_mov_b32 v129, 0
    v_mov_b32 v130, 0
    v_mov_b32 v131, 0
    v_mov_b32 v156, 163648
    s_waitcnt vmcnt(0)
    s_lshl_b32 s58, s28, 6
    s_add_u32 s58, s58, 0x1220000
    v_mov_b32 v152, s58
    v_mov_b32 v154, s56
    v_mov_b32 v155, s57
    s_mov_b64 exec, 1
    buffer_store_dwordx2 v[154:155], v152, s[12:15], 0 offen sc0 sc1
    s_mov_b64 exec, -1
    buffer_load_dword v6, v7, s[12:15], s36 offen sc1
    s_mul_i32 s3, s25, 160
    s_movk_i32 s10, 1280
    v_add_u32 v155, 0, v1
    v_mul_u32_u24 v28, 0xcccd, v155
    v_lshrrev_b32 v28, 19, v28
    v_mul_u32_u24 v29, 10, v28
    v_sub_u32 v155, v155, v29
    v_mul_lo_u32 v28, v28, s10
    v_lshl_add_u32 v155, v155, 4, v28
    v_add_u32 v152, s3, v155
    v_add_u32 v155, 64, v1
    v_mul_u32_u24 v28, 0xcccd, v155
    v_lshrrev_b32 v28, 19, v28
    v_mul_u32_u24 v29, 10, v28
    v_sub_u32 v155, v155, v29
    v_mul_lo_u32 v28, v28, s10
    v_lshl_add_u32 v155, v155, 4, v28
    v_add_u32 v153, s3, v155
    v_add_u32 v155, 128, v1
    v_mul_u32_u24 v28, 0xcccd, v155
    v_lshrrev_b32 v28, 19, v28
    v_mul_u32_u24 v29, 10, v28
    v_sub_u32 v155, v155, v29
    v_mul_lo_u32 v28, v28, s10
    v_lshl_add_u32 v155, v155, 4, v28
    v_add_u32 v154, s3, v155
    s_mov_b32 s10, 0
LW_29:
    ds_read_b32 v157, v156
    s_waitcnt lgkmcnt(0)
    v_readfirstlane_b32 s11, v157
    s_add_u32 s10, s10, 1
    s_cmp_gt_u32 s10, 240000
    s_cbranch_scc1 LWD_30
    s_cmp_lt_u32 s11, 4
    s_cbranch_scc1 LW_29
LWD_30:
    s_lshr_b32 s10, s26, 1
    s_lshl_b32 s10, s10, 2
    s_add_u32 s10, s10, 163672
    v_mov_b32 v156, s10
    s_mov_b32 s44, 0
    s_mov_b32 s45, 0
P3_WAIT:
    ds_read_b32 v157, v156
    s_waitcnt lgkmcnt(0)
    v_readfirstlane_b32 s46, v157
    s_add_u32 s45, s45, 1
    s_cmp_gt_u32 s45, 240000
    s_cselect_b32 s46, -1, s46
    s_mov_b32 s47, 0
    s_bfe_u32 s10, s46, 0x80000
    s_cmp_eq_u32 s10, 0xff
    s_cselect_b32 s10, 1, 0
    s_or_b32 s47, s47, s10
    s_bfe_u32 s10, s46, 0x80008
    s_cmp_eq_u32 s10, 0xff
    s_cselect_b32 s10, 2, 0
    s_or_b32 s47, s47, s10
    s_bfe_u32 s10, s46, 0x80010
    s_cmp_eq_u32 s10, 0xff
    s_cselect_b32 s10, 4, 0
    s_or_b32 s47, s47, s10
    s_bfe_u32 s10, s46, 0x80018
    s_cmp_eq_u32 s10, 0xff
    s_cselect_b32 s10, 8, 0
    s_or_b32 s47, s47, s10
    s_andn2_b32 s47, s47, s44
    s_cmp_eq_u32 s47, 0
    s_cbranch_scc1 P3_WAIT
    s_bitcmp0_b32 s47, 0
    s_cbranch_scc1 P3_NL0
    s_add_u32 s35, s32, 0
    s_add_u32 s33, s35, 4096
    buffer_load_dwordx4 v[32:35], v5, s[12:15], s35 offen offset:0 sc1
    buffer_load_dwordx4 v[36:39], v5, s[12:15], s35 offen offset:1024 sc1
    buffer_load_dwordx4 v[40:43], v5, s[12:15], s35 offen offset:2048 sc1
    buffer_load_dwordx4 v[44:47], v5, s[12:15], s35 offen offset:3072 sc1
    buffer_load_dwordx4 v[48:51], v5, s[12:15], s33 offen offset:0 sc1
P3_NL0:
    s_bitcmp0_b32 s47, 1
    s_cbranch_scc1 P3_NL1
    s_add_u32 s35, s32, 5120
    s_add_u32 s33, s35, 4096
    buffer_load_dwordx4 v[52:55], v5, s[12:15], s35 offen offset:0 sc1
    buffer_load_dwordx4 v[56:59], v5, s[12:15], s35 offen offset:1024 sc1
    buffer_load_dwordx4 v[60:63], v5, s[12:15], s35 offen offset:2048 sc1
    buffer_load_dwordx4 v[64:67], v5, s[12:15], s35 offen offset:3072 sc1
    buffer_load_dwordx4 v[68:71], v5, s[12:15], s33 offen offset:0 sc1
P3_NL1:
    s_bitcmp0_b32 s47, 2
    s_cbranch_scc1 P3_NL2
    s_add_u32 s35, s32, 10240
    s_add_u32 s33, s35, 4096
    buffer_load_dwordx4 v[72:75], v5, s[12:15], s35 offen offset:0 sc1
    buffer_load_dwordx4 v[76:79], v5, s[12:15], s35 offen offset:1024 sc1
    buffer_load_dwordx4 v[80:83], v5, s[12:15], s35 offen offset:2048 sc1
    buffer_load_dwordx4 v[84:87], v5, s[12:15], s35 offen offset:3072 sc1
    buffer_load_dwordx4 v[88:91], v5, s[12:15], s33 offen offset:0 sc1
P3_NL2:
    s_bitcmp0_b32 s47, 3
    s_cbranch_scc1 P3_NL3
    s_add_u32 s35, s32, 15360
    s_add_u32 s33, s35, 4096
    buffer_load_dwordx4 v[92:95], v5, s[12:15], s35 offen offset:0 sc1
    buffer_load_dwordx4 v[96:99], v5, s[12:15], s35 offen offset:1024 sc1
    buffer_load_dwordx4 v[100:103], v5, s[12:15], s35 offen offset:2048 sc1
    buffer_load_dwordx4 v[104:107], v5, s[12:15], s35 offen offset:3072 sc1
    buffer_load_dwordx4 v[108:111], v5, s[12:15], s33 offen offset:0 sc1
P3_NL3:
    s_bitcmp0_b32 s47, 0
    s_cbranch_scc1 P3_NM0
    ds_read_b64_tr_b16 v[132:133], v158 offset:0
    ds_read_b64_tr_b16 v[134:135], v159 offset:0
    ds_read_b64_tr_b16 v[136:137], v158 offset:32
    ds_read_b64_tr_b16 v[138:139], v159 offset:32
    ds_read_b64_tr_b16 v[140:141], v158 offset:64
    ds_read_b64_tr_b16 v[142:143], v159 offset:64
    ds_read_b64_tr_b16 v[144:145], v158 offset:96
    ds_read_b64_tr_b16 v[146:147], v159 offset:96
    ds_read_b64_tr_b16 v[148:149], v158 offset:128
    ds_read_b64_tr_b16 v[150:151], v159 offset:128
    s_waitcnt vmcnt(0)
    ds_read_b64_tr_b16 v[8:9], v160 offset:0
    ds_read_b64_tr_b16 v[10:11], v161 offset:0
    ds_read_b64_tr_b16 v[12:13], v160 offset:32
    ds_read_b64_tr_b16 v[14:15], v161 offset:32
    ds_read_b64_tr_b16 v[16:17], v160 offset:64
    ds_read_b64_tr_b16 v[18:19], v161 offset:64
    ds_read_b64_tr_b16 v[20:21], v160 offset:96
    ds_read_b64_tr_b16 v[22:23], v161 offset:96
    ds_read_b64_tr_b16 v[24:25], v160 offset:128
    ds_read_b64_tr_b16 v[26:27], v161 offset:128
    s_waitcnt lgkmcnt(10)
    v_mfma_f32_16x16x32_bf16 v[112:115], v[132:135], v[32:35], v[112:115]
    v_mfma_f32_16x16x32_bf16 v[116:119], v[136:139], v[32:35], v[116:119]
    v_mfma_f32_16x16x32_bf16 v[120:123], v[140:143], v[32:35], v[120:123]
    v_mfma_f32_16x16x32_bf16 v[124:127], v[144:147], v[32:35], v[124:127]
    v_mfma_f32_16x16x32_bf16 v[128:131], v[148:151], v[32:35], v[128:131]
    ds_read_b64_tr_b16 v[132:133], v162 offset:0
    ds_read_b64_tr_b16 v[134:135], v163 offset:0
    ds_read_b64_tr_b16 v[136:137], v162 offset:32
    ds_read_b64_tr_b16 v[138:139], v163 offset:32
    ds_read_b64_tr_b16 v[140:141], v162 offset:64
    ds_read_b64_tr_b16 v[142:143], v163 offset:64
    ds_read_b64_tr_b16 v[144:145], v162 offset:96
    ds_read_b64_tr_b16 v[146:147], v163 offset:96
    ds_read_b64_tr_b16 v[148:149], v162 offset:128
    ds_read_b64_tr_b16 v[150:151], v163 offset:128
    s_waitcnt lgkmcnt(10)
    v_mfma_f32_16x16x32_bf16 v[112:115], v[8:11], v[36:39], v[112:115]
    v_mfma_f32_16x16x32_bf16 v[116:119], v[12:15], v[36:39], v[116:119]
    v_mfma_f32_16x16x32_bf16 v[120:123], v[16:19], v[36:39], v[120:123]
    v_mfma_f32_16x16x32_bf16 v[124:127], v[20:23], v[36:39], v[124:127]
    v_mfma_f32_16x16x32_bf16 v[128:131], v[24:27], v[36:39], v[128:131]
    ds_read_b64_tr_b16 v[8:9], v164 offset:0
    ds_read_b64_tr_b16 v[10:11], v165 offset:0
    ds_read_b64_tr_b16 v[12:13], v164 offset:32
    ds_read_b64_tr_b16 v[14:15], v165 offset:32
    ds_read_b64_tr_b16 v[16:17], v164 offset:64
    ds_read_b64_tr_b16 v[18:19], v165 offset:64
    ds_read_b64_tr_b16 v[20:21], v164 offset:96
    ds_read_b64_tr_b16 v[22:23], v165 offset:96
    ds_read_b64_tr_b16 v[24:25], v164 offset:128
    ds_read_b64_tr_b16 v[26:27], v165 offset:128
    s_waitcnt lgkmcnt(10)
    v_mfma_f32_16x16x32_bf16 v[112:115], v[132:135], v[40:43], v[112:115]
    v_mfma_f32_16x16x32_bf16 v[116:119], v[136:139], v[40:43], v[116:119]
    v_mfma_f32_16x16x32_bf16 v[120:123], v[140:143], v[40:43], v[120:123]
    v_mfma_f32_16x16x32_bf16 v[124:127], v[144:147], v[40:43], v[124:127]
    v_mfma_f32_16x16x32_bf16 v[128:131], v[148:151], v[40:43], v[128:131]
    ds_read_b64_tr_b16 v[132:133], v166 offset:0
    ds_read_b64_tr_b16 v[134:135], v167 offset:0
    ds_read_b64_tr_b16 v[136:137], v166 offset:32
    ds_read_b64_tr_b16 v[138:139], v167 offset:32
    ds_read_b64_tr_b16 v[140:141], v166 offset:64
    ds_read_b64_tr_b16 v[142:143], v167 offset:64
    ds_read_b64_tr_b16 v[144:145], v166 offset:96
    ds_read_b64_tr_b16 v[146:147], v167 offset:96
    ds_read_b64_tr_b16 v[148:149], v166 offset:128
    ds_read_b64_tr_b16 v[150:151], v167 offset:128
    s_waitcnt lgkmcnt(10)
    v_mfma_f32_16x16x32_bf16 v[112:115], v[8:11], v[44:47], v[112:115]
    v_mfma_f32_16x16x32_bf16 v[116:119], v[12:15], v[44:47], v[116:119]
    v_mfma_f32_16x16x32_bf16 v[120:123], v[16:19], v[44:47], v[120:123]
    v_mfma_f32_16x16x32_bf16 v[124:127], v[20:23], v[44:47], v[124:127]
    v_mfma_f32_16x16x32_bf16 v[128:131], v[24:27], v[44:47], v[128:131]
    s_waitcnt lgkmcnt(0)
    v_mfma_f32_16x16x32_bf16 v[112:115], v[132:135], v[48:51], v[112:115]
    v_mfma_f32_16x16x32_bf16 v[116:119], v[136:139], v[48:51], v[116:119]
    v_mfma_f32_16x16x32_bf16 v[120:123], v[140:143], v[48:51], v[120:123]
    v_mfma_f32_16x16x32_bf16 v[124:127], v[144:147], v[48:51], v[124:127]
    v_mfma_f32_16x16x32_bf16 v[128:131], v[148:151], v[48:51], v[128:131]
P3_NM0:
    s_bitcmp0_b32 s47, 1
    s_cbranch_scc1 P3_NM1
    ds_read_b64_tr_b16 v[132:133], v158 offset:25600
    ds_read_b64_tr_b16 v[134:135], v159 offset:25600
    ds_read_b64_tr_b16 v[136:137], v158 offset:25632
    ds_read_b64_tr_b16 v[138:139], v159 offset:25632
    ds_read_b64_tr_b16 v[140:141], v158 offset:25664
    ds_read_b64_tr_b16 v[142:143], v159 offset:25664
    ds_read_b64_tr_b16 v[144:145], v158 offset:25696
    ds_read_b64_tr_b16 v[146:147], v159 offset:25696
    ds_read_b64_tr_b16 v[148:149], v158 offset:25728
    ds_read_b64_tr_b16 v[150:151], v159 offset:25728
    s_waitcnt vmcnt(0)
    ds_read_b64_tr_b16 v[8:9], v160 offset:25600
    ds_read_b64_tr_b16 v[10:11], v161 offset:25600
    ds_read_b64_tr_b16 v[12:13], v160 offset:25632
    ds_read_b64_tr_b16 v[14:15], v161 offset:25632
    ds_read_b64_tr_b16 v[16:17], v160 offset:25664
    ds_read_b64_tr_b16 v[18:19], v161 offset:25664
    ds_read_b64_tr_b16 v[20:21], v160 offset:25696
    ds_read_b64_tr_b16 v[22:23], v161 offset:25696
    ds_read_b64_tr_b16 v[24:25], v160 offset:25728
    ds_read_b64_tr_b16 v[26:27], v161 offset:25728
    s_waitcnt lgkmcnt(10)
    v_mfma_f32_16x16x32_bf16 v[112:115], v[132:135], v[52:55], v[112:115]
    v_mfma_f32_16x16x32_bf16 v[116:119], v[136:139], v[52:55], v[116:119]
    v_mfma_f32_16x16x32_bf16 v[120:123], v[140:143], v[52:55], v[120:123]
    v_mfma_f32_16x16x32_bf16 v[124:127], v[144:147], v[52:55], v[124:127]
    v_mfma_f32_16x16x32_bf16 v[128:131], v[148:151], v[52:55], v[128:131]
    ds_read_b64_tr_b16 v[132:133], v162 offset:25600
    ds_read_b64_tr_b16 v[134:135], v163 offset:25600
    ds_read_b64_tr_b16 v[136:137], v162 offset:25632
    ds_read_b64_tr_b16 v[138:139], v163 offset:25632
    ds_read_b64_tr_b16 v[140:141], v162 offset:25664
    ds_read_b64_tr_b16 v[142:143], v163 offset:25664
    ds_read_b64_tr_b16 v[144:145], v162 offset:25696
    ds_read_b64_tr_b16 v[146:147], v163 offset:25696
    ds_read_b64_tr_b16 v[148:149], v162 offset:25728
    ds_read_b64_tr_b16 v[150:151], v163 offset:25728
    s_waitcnt lgkmcnt(10)
    v_mfma_f32_16x16x32_bf16 v[112:115], v[8:11], v[56:59], v[112:115]
    v_mfma_f32_16x16x32_bf16 v[116:119], v[12:15], v[56:59], v[116:119]
    v_mfma_f32_16x16x32_bf16 v[120:123], v[16:19], v[56:59], v[120:123]
    v_mfma_f32_16x16x32_bf16 v[124:127], v[20:23], v[56:59], v[124:127]
    v_mfma_f32_16x16x32_bf16 v[128:131], v[24:27], v[56:59], v[128:131]
    ds_read_b64_tr_b16 v[8:9], v164 offset:25600
    ds_read_b64_tr_b16 v[10:11], v165 offset:25600
    ds_read_b64_tr_b16 v[12:13], v164 offset:25632
    ds_read_b64_tr_b16 v[14:15], v165 offset:25632
    ds_read_b64_tr_b16 v[16:17], v164 offset:25664
    ds_read_b64_tr_b16 v[18:19], v165 offset:25664
    ds_read_b64_tr_b16 v[20:21], v164 offset:25696
    ds_read_b64_tr_b16 v[22:23], v165 offset:25696
    ds_read_b64_tr_b16 v[24:25], v164 offset:25728
    ds_read_b64_tr_b16 v[26:27], v165 offset:25728
    s_waitcnt lgkmcnt(10)
    v_mfma_f32_16x16x32_bf16 v[112:115], v[132:135], v[60:63], v[112:115]
    v_mfma_f32_16x16x32_bf16 v[116:119], v[136:139], v[60:63], v[116:119]
    v_mfma_f32_16x16x32_bf16 v[120:123], v[140:143], v[60:63], v[120:123]
    v_mfma_f32_16x16x32_bf16 v[124:127], v[144:147], v[60:63], v[124:127]
    v_mfma_f32_16x16x32_bf16 v[128:131], v[148:151], v[60:63], v[128:131]
    ds_read_b64_tr_b16 v[132:133], v166 offset:25600
    ds_read_b64_tr_b16 v[134:135], v167 offset:25600
    ds_read_b64_tr_b16 v[136:137], v166 offset:25632
    ds_read_b64_tr_b16 v[138:139], v167 offset:25632
    ds_read_b64_tr_b16 v[140:141], v166 offset:25664
    ds_read_b64_tr_b16 v[142:143], v167 offset:25664
    ds_read_b64_tr_b16 v[144:145], v166 offset:25696
    ds_read_b64_tr_b16 v[146:147], v167 offset:25696
    ds_read_b64_tr_b16 v[148:149], v166 offset:25728
    ds_read_b64_tr_b16 v[150:151], v167 offset:25728
    s_waitcnt lgkmcnt(10)
    v_mfma_f32_16x16x32_bf16 v[112:115], v[8:11], v[64:67], v[112:115]
    v_mfma_f32_16x16x32_bf16 v[116:119], v[12:15], v[64:67], v[116:119]
    v_mfma_f32_16x16x32_bf16 v[120:123], v[16:19], v[64:67], v[120:123]
    v_mfma_f32_16x16x32_bf16 v[124:127], v[20:23], v[64:67], v[124:127]
    v_mfma_f32_16x16x32_bf16 v[128:131], v[24:27], v[64:67], v[128:131]
    s_waitcnt lgkmcnt(0)
    v_mfma_f32_16x16x32_bf16 v[112:115], v[132:135], v[68:71], v[112:115]
    v_mfma_f32_16x16x32_bf16 v[116:119], v[136:139], v[68:71], v[116:119]
    v_mfma_f32_16x16x32_bf16 v[120:123], v[140:143], v[68:71], v[120:123]
    v_mfma_f32_16x16x32_bf16 v[124:127], v[144:147], v[68:71], v[124:127]
    v_mfma_f32_16x16x32_bf16 v[128:131], v[148:151], v[68:71], v[128:131]
P3_NM1:
    s_bitcmp0_b32 s47, 2
    s_cbranch_scc1 P3_NM2
    v_add_u32 v158, 51200, v158
    v_add_u32 v159, 51200, v159
    v_add_u32 v160, 51200, v160
    v_add_u32 v161, 51200, v161
    v_add_u32 v162, 51200, v162
    v_add_u32 v163, 51200, v163
    v_add_u32 v164, 51200, v164
    v_add_u32 v165, 51200, v165
    v_add_u32 v166, 51200, v166
    v_add_u32 v167, 51200, v167
    ds_read_b64_tr_b16 v[132:133], v158 offset:0
    ds_read_b64_tr_b16 v[134:135], v159 offset:0
    ds_read_b64_tr_b16 v[136:137], v158 offset:32
    ds_read_b64_tr_b16 v[138:139], v159 offset:32
    ds_read_b64_tr_b16 v[140:141], v158 offset:64
    ds_read_b64_tr_b16 v[142:143], v159 offset:64
    ds_read_b64_tr_b16 v[144:145], v158 offset:96
    ds_read_b64_tr_b16 v[146:147], v159 offset:96
    ds_read_b64_tr_b16 v[148:149], v158 offset:128
    ds_read_b64_tr_b16 v[150:151], v159 offset:128
    s_waitcnt vmcnt(0)
    ds_read_b64_tr_b16 v[8:9], v160 offset:0
    ds_read_b64_tr_b16 v[10:11], v161 offset:0
    ds_read_b64_tr_b16 v[12:13], v160 offset:32
    ds_read_b64_tr_b16 v[14:15], v161 offset:32
    ds_read_b64_tr_b16 v[16:17], v160 offset:64
    ds_read_b64_tr_b16 v[18:19], v161 offset:64
    ds_read_b64_tr_b16 v[20:21], v160 offset:96
    ds_read_b64_tr_b16 v[22:23], v161 offset:96
    ds_read_b64_tr_b16 v[24:25], v160 offset:128
    ds_read_b64_tr_b16 v[26:27], v161 offset:128
    s_waitcnt lgkmcnt(10)
    v_mfma_f32_16x16x32_bf16 v[112:115], v[132:135], v[72:75], v[112:115]
    v_mfma_f32_16x16x32_bf16 v[116:119], v[136:139], v[72:75], v[116:119]
    v_mfma_f32_16x16x32_bf16 v[120:123], v[140:143], v[72:75], v[120:123]
    v_mfma_f32_16x16x32_bf16 v[124:127], v[144:147], v[72:75], v[124:127]
    v_mfma_f32_16x16x32_bf16 v[128:131], v[148:151], v[72:75], v[128:131]
    ds_read_b64_tr_b16 v[132:133], v162 offset:0
    ds_read_b64_tr_b16 v[134:135], v163 offset:0
    ds_read_b64_tr_b16 v[136:137], v162 offset:32
    ds_read_b64_tr_b16 v[138:139], v163 offset:32
    ds_read_b64_tr_b16 v[140:141], v162 offset:64
    ds_read_b64_tr_b16 v[142:143], v163 offset:64
    ds_read_b64_tr_b16 v[144:145], v162 offset:96
    ds_read_b64_tr_b16 v[146:147], v163 offset:96
    ds_read_b64_tr_b16 v[148:149], v162 offset:128
    ds_read_b64_tr_b16 v[150:151], v163 offset:128
    s_waitcnt lgkmcnt(10)
    v_mfma_f32_16x16x32_bf16 v[112:115], v[8:11], v[76:79], v[112:115]
    v_mfma_f32_16x16x32_bf16 v[116:119], v[12:15], v[76:79], v[116:119]
    v_mfma_f32_16x16x32_bf16 v[120:123], v[16:19], v[76:79], v[120:123]
    v_mfma_f32_16x16x32_bf16 v[124:127], v[20:23], v[76:79], v[124:127]
    v_mfma_f32_16x16x32_bf16 v[128:131], v[24:27], v[76:79], v[128:131]
    ds_read_b64_tr_b16 v[8:9], v164 offset:0
    ds_read_b64_tr_b16 v[10:11], v165 offset:0
    ds_read_b64_tr_b16 v[12:13], v164 offset:32
    ds_read_b64_tr_b16 v[14:15], v165 offset:32
    ds_read_b64_tr_b16 v[16:17], v164 offset:64
    ds_read_b64_tr_b16 v[18:19], v165 offset:64
    ds_read_b64_tr_b16 v[20:21], v164 offset:96
    ds_read_b64_tr_b16 v[22:23], v165 offset:96
    ds_read_b64_tr_b16 v[24:25], v164 offset:128
    ds_read_b64_tr_b16 v[26:27], v165 offset:128
    s_waitcnt lgkmcnt(10)
    v_mfma_f32_16x16x32_bf16 v[112:115], v[132:135], v[80:83], v[112:115]
    v_mfma_f32_16x16x32_bf16 v[116:119], v[136:139], v[80:83], v[116:119]
    v_mfma_f32_16x16x32_bf16 v[120:123], v[140:143], v[80:83], v[120:123]
    v_mfma_f32_16x16x32_bf16 v[124:127], v[144:147], v[80:83], v[124:127]
    v_mfma_f32_16x16x32_bf16 v[128:131], v[148:151], v[80:83], v[128:131]
    ds_read_b64_tr_b16 v[132:133], v166 offset:0
    ds_read_b64_tr_b16 v[134:135], v167 offset:0
    ds_read_b64_tr_b16 v[136:137], v166 offset:32
    ds_read_b64_tr_b16 v[138:139], v167 offset:32
    ds_read_b64_tr_b16 v[140:141], v166 offset:64
    ds_read_b64_tr_b16 v[142:143], v167 offset:64
    ds_read_b64_tr_b16 v[144:145], v166 offset:96
    ds_read_b64_tr_b16 v[146:147], v167 offset:96
    ds_read_b64_tr_b16 v[148:149], v166 offset:128
    ds_read_b64_tr_b16 v[150:151], v167 offset:128
    s_waitcnt lgkmcnt(10)
    v_mfma_f32_16x16x32_bf16 v[112:115], v[8:11], v[84:87], v[112:115]
    v_mfma_f32_16x16x32_bf16 v[116:119], v[12:15], v[84:87], v[116:119]
    v_mfma_f32_16x16x32_bf16 v[120:123], v[16:19], v[84:87], v[120:123]
    v_mfma_f32_16x16x32_bf16 v[124:127], v[20:23], v[84:87], v[124:127]
    v_mfma_f32_16x16x32_bf16 v[128:131], v[24:27], v[84:87], v[128:131]
    s_waitcnt lgkmcnt(0)
    v_mfma_f32_16x16x32_bf16 v[112:115], v[132:135], v[88:91], v[112:115]
    v_mfma_f32_16x16x32_bf16 v[116:119], v[136:139], v[88:91], v[116:119]
    v_mfma_f32_16x16x32_bf16 v[120:123], v[140:143], v[88:91], v[120:123]
    v_mfma_f32_16x16x32_bf16 v[124:127], v[144:147], v[88:91], v[124:127]
    v_mfma_f32_16x16x32_bf16 v[128:131], v[148:151], v[88:91], v[128:131]
    v_subrev_u32 v158, 51200, v158
    v_subrev_u32 v159, 51200, v159
    v_subrev_u32 v160, 51200, v160
    v_subrev_u32 v161, 51200, v161
    v_subrev_u32 v162, 51200, v162
    v_subrev_u32 v163, 51200, v163
    v_subrev_u32 v164, 51200, v164
    v_subrev_u32 v165, 51200, v165
    v_subrev_u32 v166, 51200, v166
    v_subrev_u32 v167, 51200, v167
P3_NM2:
    s_bitcmp0_b32 s47, 3
    s_cbranch_scc1 P3_NM3
    v_add_u32 v158, 51200, v158
    v_add_u32 v159, 51200, v159
    v_add_u32 v160, 51200, v160
    v_add_u32 v161, 51200, v161
    v_add_u32 v162, 51200, v162
    v_add_u32 v163, 51200, v163
    v_add_u32 v164, 51200, v164
    v_add_u32 v165, 51200, v165
    v_add_u32 v166, 51200, v166
    v_add_u32 v167, 51200, v167
    ds_read_b64_tr_b16 v[132:133], v158 offset:25600
    ds_read_b64_tr_b16 v[134:135], v159 offset:25600
    ds_read_b64_tr_b16 v[136:137], v158 offset:25632
    ds_read_b64_tr_b16 v[138:139], v159 offset:25632
    ds_read_b64_tr_b16 v[140:141], v158 offset:25664
    ds_read_b64_tr_b16 v[142:143], v159 offset:25664
    ds_read_b64_tr_b16 v[144:145], v158 offset:25696
    ds_read_b64_tr_b16 v[146:147], v159 offset:25696
    ds_read_b64_tr_b16 v[148:149], v158 offset:25728
    ds_read_b64_tr_b16 v[150:151], v159 offset:25728
    s_waitcnt vmcnt(0)
    ds_read_b64_tr_b16 v[8:9], v160 offset:25600
    ds_read_b64_tr_b16 v[10:11], v161 offset:25600
    ds_read_b64_tr_b16 v[12:13], v160 offset:25632
    ds_read_b64_tr_b16 v[14:15], v161 offset:25632
    ds_read_b64_tr_b16 v[16:17], v160 offset:25664
    ds_read_b64_tr_b16 v[18:19], v161 offset:25664
    ds_read_b64_tr_b16 v[20:21], v160 offset:25696
    ds_read_b64_tr_b16 v[22:23], v161 offset:25696
    ds_read_b64_tr_b16 v[24:25], v160 offset:25728
    ds_read_b64_tr_b16 v[26:27], v161 offset:25728
    s_waitcnt lgkmcnt(10)
    v_mfma_f32_16x16x32_bf16 v[112:115], v[132:135], v[92:95], v[112:115]
    v_mfma_f32_16x16x32_bf16 v[116:119], v[136:139], v[92:95], v[116:119]
    v_mfma_f32_16x16x32_bf16 v[120:123], v[140:143], v[92:95], v[120:123]
    v_mfma_f32_16x16x32_bf16 v[124:127], v[144:147], v[92:95], v[124:127]
    v_mfma_f32_16x16x32_bf16 v[128:131], v[148:151], v[92:95], v[128:131]
    ds_read_b64_tr_b16 v[132:133], v162 offset:25600
    ds_read_b64_tr_b16 v[134:135], v163 offset:25600
    ds_read_b64_tr_b16 v[136:137], v162 offset:25632
    ds_read_b64_tr_b16 v[138:139], v163 offset:25632
    ds_read_b64_tr_b16 v[140:141], v162 offset:25664
    ds_read_b64_tr_b16 v[142:143], v163 offset:25664
    ds_read_b64_tr_b16 v[144:145], v162 offset:25696
    ds_read_b64_tr_b16 v[146:147], v163 offset:25696
    ds_read_b64_tr_b16 v[148:149], v162 offset:25728
    ds_read_b64_tr_b16 v[150:151], v163 offset:25728
    s_waitcnt lgkmcnt(10)
    v_mfma_f32_16x16x32_bf16 v[112:115], v[8:11], v[96:99], v[112:115]
    v_mfma_f32_16x16x32_bf16 v[116:119], v[12:15], v[96:99], v[116:119]
    v_mfma_f32_16x16x32_bf16 v[120:123], v[16:19], v[96:99], v[120:123]
    v_mfma_f32_16x16x32_bf16 v[124:127], v[20:23], v[96:99], v[124:127]
    v_mfma_f32_16x16x32_bf16 v[128:131], v[24:27], v[96:99], v[128:131]
    ds_read_b64_tr_b16 v[8:9], v164 offset:25600
    ds_read_b64_tr_b16 v[10:11], v165 offset:25600
    ds_read_b64_tr_b16 v[12:13], v164 offset:25632
    ds_read_b64_tr_b16 v[14:15], v165 offset:25632
    ds_read_b64_tr_b16 v[16:17], v164 offset:25664
    ds_read_b64_tr_b16 v[18:19], v165 offset:25664
    ds_read_b64_tr_b16 v[20:21], v164 offset:25696
    ds_read_b64_tr_b16 v[22:23], v165 offset:25696
    ds_read_b64_tr_b16 v[24:25], v164 offset:25728
    ds_read_b64_tr_b16 v[26:27], v165 offset:25728
    s_waitcnt lgkmcnt(10)
    v_mfma_f32_16x16x32_bf16 v[112:115], v[132:135], v[100:103], v[112:115]
    v_mfma_f32_16x16x32_bf16 v[116:119], v[136:139], v[100:103], v[116:119]
    v_mfma_f32_16x16x32_bf16 v[120:123], v[140:143], v[100:103], v[120:123]
    v_mfma_f32_16x16x32_bf16 v[124:127], v[144:147], v[100:103], v[124:127]
    v_mfma_f32_16x16x32_bf16 v[128:131], v[148:151], v[100:103], v[128:131]
    ds_read_b64_tr_b16 v[132:133], v166 offset:25600
    ds_read_b64_tr_b16 v[134:135], v167 offset:25600
    ds_read_b64_tr_b16 v[136:137], v166 offset:25632
    ds_read_b64_tr_b16 v[138:139], v167 offset:25632
    ds_read_b64_tr_b16 v[140:141], v166 offset:25664
    ds_read_b64_tr_b16 v[142:143], v167 offset:25664
    ds_read_b64_tr_b16 v[144:145], v166 offset:25696
    ds_read_b64_tr_b16 v[146:147], v167 offset:25696
    ds_read_b64_tr_b16 v[148:149], v166 offset:25728
    ds_read_b64_tr_b16 v[150:151], v167 offset:25728
    s_waitcnt lgkmcnt(10)
    v_mfma_f32_16x16x32_bf16 v[112:115], v[8:11], v[104:107], v[112:115]
    v_mfma_f32_16x16x32_bf16 v[116:119], v[12:15], v[104:107], v[116:119]
    v_mfma_f32_16x16x32_bf16 v[120:123], v[16:19], v[104:107], v[120:123]
    v_mfma_f32_16x16x32_bf16 v[124:127], v[20:23], v[104:107], v[124:127]
    v_mfma_f32_16x16x32_bf16 v[128:131], v[24:27], v[104:107], v[128:131]
    s_waitcnt lgkmcnt(0)
    v_mfma_f32_16x16x32_bf16 v[112:115], v[132:135], v[108:111], v[112:115]
    v_mfma_f32_16x16x32_bf16 v[116:119], v[136:139], v[108:111], v[116:119]
    v_mfma_f32_16x16x32_bf16 v[120:123], v[140:143], v[108:111], v[120:123]
    v_mfma_f32_16x16x32_bf16 v[124:127], v[144:147], v[108:111], v[124:127]
    v_mfma_f32_16x16x32_bf16 v[128:131], v[148:151], v[108:111], v[128:131]
    v_subrev_u32 v158, 51200, v158
    v_subrev_u32 v159, 51200, v159
    v_subrev_u32 v160, 51200, v160
    v_subrev_u32 v161, 51200, v161
    v_subrev_u32 v162, 51200, v162
    v_subrev_u32 v163, 51200, v163
    v_subrev_u32 v164, 51200, v164
    v_subrev_u32 v165, 51200, v165
    v_subrev_u32 v166, 51200, v166
    v_subrev_u32 v167, 51200, v167
P3_NM3:
    s_or_b32 s44, s44, s47
    s_cmp_lg_u32 s44, 15
    s_cbranch_scc1 P3_WAIT
    ds_read_b64 v[32:33], v31 offset:0
    ds_read_b64_tr_b16 v[44:45], v30 offset:0
    ds_read_b64 v[34:35], v31 offset:32
    ds_read_b64_tr_b16 v[46:47], v30 offset:2048
    ds_read_b64 v[36:37], v31 offset:64
    ds_read_b64_tr_b16 v[48:49], v30 offset:4096
    ds_read_b64 v[38:39], v31 offset:96
    ds_read_b64_tr_b16 v[50:51], v30 offset:6144
    ds_read_b64 v[40:41], v31 offset:128
    ds_read_b64_tr_b16 v[52:53], v30 offset:8192
    v_sub_f32 v17, 1.0, v6
    s_mov_b32 s42, 0xffff0000
    s_waitcnt lgkmcnt(0)
    v_lshlrev_b32 v18, 16, v32
    v_lshlrev_b32 v19, 16, v44
    v_mul_f32 v18, v18, v19
    v_mul_f32 v18, v18, v17
    v_fma_f32 v112, v112, v6, v18
    v_and_b32 v18, s42, v32
    v_and_b32 v19, s42, v44
    v_mul_f32 v18, v18, v19
    v_mul_f32 v18, v18, v17
    v_fma_f32 v113, v113, v6, v18
    v_lshlrev_b32 v18, 16, v33
    v_lshlrev_b32 v19, 16, v45
    v_mul_f32 v18, v18, v19
    v_mul_f32 v18, v18, v17
    v_fma_f32 v114, v114, v6, v18
    v_and_b32 v18, s42, v33
    v_and_b32 v19, s42, v45
    v_mul_f32 v18, v18, v19
    v_mul_f32 v18, v18, v17
    v_fma_f32 v115, v115, v6, v18
    v_cvt_pk_bf16_f32 v56, v112, v113
    v_cvt_pk_bf16_f32 v57, v114, v115
    ds_write_b64 v31, v[56:57] offset:0
    v_lshlrev_b32 v18, 16, v34
    v_lshlrev_b32 v19, 16, v46
    v_mul_f32 v18, v18, v19
    v_mul_f32 v18, v18, v17
    v_fma_f32 v116, v116, v6, v18
    v_and_b32 v18, s42, v34
    v_and_b32 v19, s42, v46
    v_mul_f32 v18, v18, v19
    v_mul_f32 v18, v18, v17
    v_fma_f32 v117, v117, v6, v18
    v_lshlrev_b32 v18, 16, v35
    v_lshlrev_b32 v19, 16, v47
    v_mul_f32 v18, v18, v19
    v_mul_f32 v18, v18, v17
    v_fma_f32 v118, v118, v6, v18
    v_and_b32 v18, s42, v35
    v_and_b32 v19, s42, v47
    v_mul_f32 v18, v18, v19
    v_mul_f32 v18, v18, v17
    v_fma_f32 v119, v119, v6, v18
    v_cvt_pk_bf16_f32 v58, v116, v117
    v_cvt_pk_bf16_f32 v59, v118, v119
    ds_write_b64 v31, v[58:59] offset:32
    v_lshlrev_b32 v18, 16, v36
    v_lshlrev_b32 v19, 16, v48
    v_mul_f32 v18, v18, v19
    v_mul_f32 v18, v18, v17
    v_fma_f32 v120, v120, v6, v18
    v_and_b32 v18, s42, v36
    v_and_b32 v19, s42, v48
    v_mul_f32 v18, v18, v19
    v_mul_f32 v18, v18, v17
    v_fma_f32 v121, v121, v6, v18
    v_lshlrev_b32 v18, 16, v37
    v_lshlrev_b32 v19, 16, v49
    v_mul_f32 v18, v18, v19
    v_mul_f32 v18, v18, v17
    v_fma_f32 v122, v122, v6, v18
    v_and_b32 v18, s42, v37
    v_and_b32 v19, s42, v49
    v_mul_f32 v18, v18, v19
    v_mul_f32 v18, v18, v17
    v_fma_f32 v123, v123, v6, v18
    v_cvt_pk_bf16_f32 v60, v120, v121
    v_cvt_pk_bf16_f32 v61, v122, v123
    ds_write_b64 v31, v[60:61] offset:64
    v_lshlrev_b32 v18, 16, v38
    v_lshlrev_b32 v19, 16, v50
    v_mul_f32 v18, v18, v19
    v_mul_f32 v18, v18, v17
    v_fma_f32 v124, v124, v6, v18
    v_and_b32 v18, s42, v38
    v_and_b32 v19, s42, v50
    v_mul_f32 v18, v18, v19
    v_mul_f32 v18, v18, v17
    v_fma_f32 v125, v125, v6, v18
    v_lshlrev_b32 v18, 16, v39
    v_lshlrev_b32 v19, 16, v51
    v_mul_f32 v18, v18, v19
    v_mul_f32 v18, v18, v17
    v_fma_f32 v126, v126, v6, v18
    v_and_b32 v18, s42, v39
    v_and_b32 v19, s42, v51
    v_mul_f32 v18, v18, v19
    v_mul_f32 v18, v18, v17
    v_fma_f32 v127, v127, v6, v18
    v_cvt_pk_bf16_f32 v62, v124, v125
    v_cvt_pk_bf16_f32 v63, v126, v127
    ds_write_b64 v31, v[62:63] offset:96
    v_lshlrev_b32 v18, 16, v40
    v_lshlrev_b32 v19, 16, v52
    v_mul_f32 v18, v18, v19
    v_mul_f32 v18, v18, v17
    v_fma_f32 v128, v128, v6, v18
    v_and_b32 v18, s42, v40
    v_and_b32 v19, s42, v52
    v_mul_f32 v18, v18, v19
    v_mul_f32 v18, v18, v17
    v_fma_f32 v129, v129, v6, v18
    v_lshlrev_b32 v18, 16, v41
    v_lshlrev_b32 v19, 16, v53
    v_mul_f32 v18, v18, v19
    v_mul_f32 v18, v18, v17
    v_fma_f32 v130, v130, v6, v18
    v_and_b32 v18, s42, v41
    v_and_b32 v19, s42, v53
    v_mul_f32 v18, v18, v19
    v_mul_f32 v18, v18, v17
    v_fma_f32 v131, v131, v6, v18
    v_cvt_pk_bf16_f32 v64, v128, v129
    v_cvt_pk_bf16_f32 v65, v130, v131
    ds_write_b64 v31, v[64:65] offset:128
    v_add_u32 v18, s41, v5
    s_waitcnt lgkmcnt(0)
    ds_read_b128 v[68:71], v18 offset:0
    ds_read_b128 v[72:75], v18 offset:1024
    ds_read_b128 v[76:79], v18 offset:2048
    s_waitcnt lgkmcnt(0)
    buffer_store_dwordx4 v[68:71], v152, s[16:19], s40 offen
    buffer_store_dwordx4 v[72:75], v153, s[16:19], s40 offen
    s_mov_b32 exec_hi, 0
    buffer_store_dwordx4 v[76:79], v154, s[16:19], s40 offen
    s_endpgm
P2_DONE_HI:
    s_waitcnt vmcnt(0)
    s_lshl_b32 s58, s28, 6
    s_add_u32 s58, s58, 0x1220000
    v_mov_b32 v4, s58
    v_mov_b32 v6, s56
    v_mov_b32 v7, s57
    s_mov_b64 exec, 1
    buffer_store_dwordx2 v[6:7], v4, s[12:15], 0 offen sc0 sc1
    s_mov_b64 exec, -1
    s_endpgm
P2_HELP:
    s_setprio 3
    s_mov_b32 s16, s4
    s_and_b32 s17, s5, 0xffff
    s_mov_b32 s18, 0x280000
    s_mov_b32 s19, 0x00020000
    s_mov_b32 s28, s74
    s_and_b32 s29, s75, 0xffff
    s_mov_b32 s30, 0x500
    s_mov_b32 s31, 0x00020000
    s_mov_b32 s36, s60
    s_and_b32 s37, s61, 0xffff
    s_mov_b32 s38, 0xc8000
    s_mov_b32 s39, 0x00020000
    s_sub_u32 s34, s26, 8
    v_lshlrev_b32 v4, 4, v1
    s_lshl_b32 s10, s2, 3
    s_lshl_b32 s11, s34, 1
    s_add_u32 s35, s10, s11
    s_mul_i32 s10, s35, 1280
    s_add_u32 s11, s10, 1280
    v_add_u32 v5, 1024, v4
    v_cmp_gt_u32 vcc, 16, v1
    v_mov_b32 v6, 0x7f000000
    s_nop 0
    v_cndmask_b32 v5, v6, v5, vcc
    v_mov_b32 v9, v5
    s_mov_b32 s46, s10
    s_mov_b32 s47, s11
    s_lshr_b32 s10, s24, 3
    v_and_b32 v5, 15, v1
    v_bfe_u32 v6, v1, 4, 1
    v_lshlrev_b32 v6, 6, v6
    v_add3_u32 v5, v5, v6, 64
    v_and_b32 v6, 1, v1
    s_lshl_b32 s11, s25, 1
    v_add_u32 v6, s11, v6
    v_cmp_gt_u32 vcc, 32, v1
    s_lshl_b32 s10, s10, 4
    s_nop 0
    v_cndmask_b32 v5, v6, v5, vcc
    v_add_u32 v5, s10, v5
    v_lshlrev_b32 v5, 6, v5
    v_add_u32 v5, 0x1210000, v5
    v_and_b32 v11, 3, v1
    v_min_u32 v11, 2, v11
    v_lshlrev_b32 v11, 6, v11
    v_bfe_u32 v12, v1, 2, 1
    v_add3_u32 v11, v11, v12, s10
    v_add_u32 v11, s11, v11
    v_lshlrev_b32 v11, 6, v11
    v_add_u32 v13, 0x1210000, v11
    s_mul_i32 s40, s34, 6144
    v_add_u32 v10, s40, v4
    s_mov_b32 s41, s25
    s_mov_b32 s42, 0
    s_mul_i32 s3, s25, 160
    s_movk_i32 s10, 1280
    v_add_u32 v7, 0, v1
    v_mul_u32_u24 v8, 0xcccd, v7
    v_lshrrev_b32 v8, 19, v8
    v_mul_u32_u24 v11, 10, v8
    v_sub_u32 v7, v7, v11
    v_mul_lo_u32 v8, v8, s10
    v_lshl_add_u32 v7, v7, 4, v8
    v_add_u32 v24, s3, v7
    v_add_u32 v7, 64, v1
    v_mul_u32_u24 v8, 0xcccd, v7
    v_lshrrev_b32 v8, 19, v8
    v_mul_u32_u24 v11, 10, v8
    v_sub_u32 v7, v7, v11
    v_mul_lo_u32 v8, v8, s10
    v_lshl_add_u32 v7, v7, 4, v8
    v_add_u32 v25, s3, v7
    v_add_u32 v7, 128, v1
    v_mul_u32_u24 v8, 0xcccd, v7
    v_lshrrev_b32 v8, 19, v8
    v_mul_u32_u24 v11, 10, v8
    v_sub_u32 v7, v7, v11
    v_mul_lo_u32 v8, v8, s10
    v_lshl_add_u32 v7, v7, 4, v8
    v_add_u32 v26, s3, v7
    v_add_u32 v7, 192, v1
    v_mul_u32_u24 v8, 0xcccd, v7
    v_lshrrev_b32 v8, 19, v8
    v_mul_u32_u24 v11, 10, v8
    v_sub_u32 v7, v7, v11
    v_mul_lo_u32 v8, v8, s10
    v_lshl_add_u32 v7, v7, 4, v8
    v_add_u32 v27, s3, v7
    v_add_u32 v7, 256, v1
    v_mul_u32_u24 v8, 0xcccd, v7
    v_lshrrev_b32 v8, 19, v8
    v_mul_u32_u24 v11, 10, v8
    v_sub_u32 v7, v7, v11
    v_mul_lo_u32 v8, v8, s10
    v_lshl_add_u32 v7, v7, 4, v8
    v_add_u32 v28, s3, v7
    s_lshl_b32 s44, s24, 11
    s_lshl_b32 s11, s25, 8
    s_add_u32 s44, s44, s11
    s_mul_i32 s44, s44, 48
    s_mul_i32 s45, s34, 3072
    s_add_u32 s44, s44, s45
    v_mov_b32 v6, 163600
    s_mov_b32 s10, 0
LW_31:
    ds_read_b32 v7, v6
    s_waitcnt lgkmcnt(0)
    v_readfirstlane_b32 s11, v7
    s_add_u32 s10, s10, 1
    s_cmp_gt_u32 s10, 240000
    s_cbranch_scc1 LWD_32
    s_cmp_lt_u32 s11, 4
    s_cbranch_scc1 LW_31
LWD_32:
    v_mov_b32 v6, 163656
    s_cmp_lg_u32 s26, 8
    s_cbranch_scc1 SP_33
    s_mov_b32 s10, 0
POLL_35:
    buffer_load_dwordx2 v[20:21], v13, s[12:15], 0 offen sc0 sc1
POLLC_37:
    s_waitcnt vmcnt(0)
    v_cmp_ne_u64 vcc, s[56:57], v[20:21]
    s_add_u32 s10, s10, 1
    s_cmp_gt_u32 s10, 30000
    s_cbranch_scc1 POLLD_36
    s_cmp_lg_u64 vcc, 0
    s_cbranch_scc1 POLL_35
POLLD_36:
    v_mov_b32 v7, 1
    ds_write_b32 v6, v7
    s_branch SPD_34
SP_33:
    s_mov_b32 s10, 0
LW_38:
    ds_read_b32 v7, v6
    s_waitcnt lgkmcnt(0)
    v_readfirstlane_b32 s11, v7
    s_add_u32 s10, s10, 1
    s_cmp_gt_u32 s10, 240000
    s_cbranch_scc1 LWD_39
    s_cmp_lt_u32 s11, 1
    s_cbranch_scc1 LW_38
LWD_39:
SPD_34:
    s_add_u32 m0, s45, 150896
    s_nop 0
    buffer_load_dwordx4 v4, s[12:15], s44 offen sc1 lds
    buffer_load_dwordx4 v4, s[12:15], s44 offen offset:1024 sc1 lds
    buffer_load_dwordx4 v4, s[12:15], s44 offen offset:2048 sc1 lds
    s_mul_i32 s43, s41, 24576
    s_add_u32 s43, s43, s27
    s_add_u32 m0, s42, s40
    s_add_u32 s41, s41, 1
    buffer_load_dwordx4 v10, s[12:15], s43 offen sc1 lds
    buffer_load_dwordx4 v10, s[12:15], s43 offen offset:1024 sc1 lds
    buffer_load_dwordx4 v10, s[12:15], s43 offen offset:2048 sc1 lds
    buffer_load_dwordx4 v10, s[12:15], s43 offen offset:3072 sc1 lds
    s_add_u32 m0, m0, 4096
    s_add_u32 s43, s43, 4096
    s_and_b32 s41, s41, 7
    buffer_load_dwordx4 v10, s[12:15], s43 offen sc1 lds
    buffer_load_dwordx4 v10, s[12:15], s43 offen offset:1024 sc1 lds
    s_add_u32 s42, s42, 24576
    s_cmp_ge_u32 s42, 73728
    s_cselect_b32 s42, 0, s42
    buffer_load_dwordx4 v[64:67], v4, s[28:31], 0 offen
    buffer_load_dwordx4 v[68:71], v9, s[28:31], 0 offen
    buffer_load_dwordx4 v[72:75], v4, s[16:19], s46 offen
    buffer_load_dwordx4 v[76:79], v9, s[16:19], s46 offen
    buffer_load_dwordx4 v[80:83], v4, s[16:19], s47 offen
    buffer_load_dwordx4 v[84:87], v9, s[16:19], s47 offen
    s_waitcnt vmcnt(6)
    s_barrier
    v_mov_b32 v6, 163660
    s_cmp_lg_u32 s26, 8
    s_cbranch_scc1 SP_40
    s_mov_b32 s10, 0
POLL_42:
    buffer_load_dwordx2 v[20:21], v5, s[12:15], 0 offen sc0 sc1
POLLC_44:
    s_waitcnt vmcnt(0)
    v_cmp_ne_u64 vcc, s[56:57], v[20:21]
    s_add_u32 s10, s10, 1
    s_cmp_gt_u32 s10, 30000
    s_cbranch_scc1 POLLD_43
    s_cmp_lg_u64 vcc, 0
    s_cbranch_scc1 POLL_42
POLLD_43:
    v_mov_b32 v7, 1
    ds_write_b32 v6, v7
    s_branch SPD_41
SP_40:
    s_mov_b32 s10, 0
LW_45:
    ds_read_b32 v7, v6
    s_waitcnt lgkmcnt(0)
    v_readfirstlane_b32 s11, v7
    s_add_u32 s10, s10, 1
    s_cmp_gt_u32 s10, 240000
    s_cbranch_scc1 LWD_46
    s_cmp_lt_u32 s11, 1
    s_cbranch_scc1 LW_45
LWD_46:
SPD_41:
    s_mul_i32 s43, s41, 24576
    s_add_u32 s43, s43, s27
    s_add_u32 m0, s42, s40
    s_add_u32 s41, s41, 1
    buffer_load_dwordx4 v10, s[12:15], s43 offen sc1 lds
    buffer_load_dwordx4 v10, s[12:15], s43 offen offset:1024 sc1 lds
    buffer_load_dwordx4 v10, s[12:15], s43 offen offset:2048 sc1 lds
    buffer_load_dwordx4 v10, s[12:15], s43 offen offset:3072 sc1 lds
    s_add_u32 m0, m0, 4096
    s_add_u32 s43, s43, 4096
    s_and_b32 s41, s41, 7
    buffer_load_dwordx4 v10, s[12:15], s43 offen sc1 lds
    buffer_load_dwordx4 v10, s[12:15], s43 offen offset:1024 sc1 lds
    s_add_u32 s42, s42, 24576
    s_cmp_ge_u32 s42, 73728
    s_cselect_b32 s42, 0, s42
    v_mov_b32 v20, 0
    v_mov_b32 v21, 0
    s_waitcnt vmcnt(6)
    v_dot2_f32_bf16 v20, v72, v64, v20
    v_dot2_f32_bf16 v21, v80, v64, v21
    v_dot2_f32_bf16 v20, v73, v65, v20
    v_dot2_f32_bf16 v21, v81, v65, v21
    v_dot2_f32_bf16 v20, v74, v66, v20
    v_dot2_f32_bf16 v21, v82, v66, v21
    v_dot2_f32_bf16 v20, v75, v67, v20
    v_dot2_f32_bf16 v21, v83, v67, v21
    v_dot2_f32_bf16 v20, v76, v68, v20
    v_dot2_f32_bf16 v21, v84, v68, v21
    v_dot2_f32_bf16 v20, v77, v69, v20
    v_dot2_f32_bf16 v21, v85, v69, v21
    v_dot2_f32_bf16 v20, v78, v70, v20
    v_dot2_f32_bf16 v21, v86, v70, v21
    v_dot2_f32_bf16 v20, v79, v71, v20
    v_dot2_f32_bf16 v21, v87, v71, v21
    s_nop 3
    v_add_f32_dpp v20, v20, v20 row_shr:1 row_mask:0xf bank_mask:0xf bound_ctrl:0
    v_add_f32_dpp v21, v21, v21 row_shr:1 row_mask:0xf bank_mask:0xf bound_ctrl:0
    s_nop 1
    v_add_f32_dpp v20, v20, v20 row_shr:2 row_mask:0xf bank_mask:0xf bound_ctrl:0
    v_add_f32_dpp v21, v21, v21 row_shr:2 row_mask:0xf bank_mask:0xf bound_ctrl:0
    s_nop 1
    v_add_f32_dpp v20, v20, v20 row_shr:4 row_mask:0xf bank_mask:0xf bound_ctrl:0
    v_add_f32_dpp v21, v21, v21 row_shr:4 row_mask:0xf bank_mask:0xf bound_ctrl:0
    s_nop 1
    v_add_f32_dpp v20, v20, v20 row_shr:8 row_mask:0xf bank_mask:0xf bound_ctrl:0
    v_add_f32_dpp v21, v21, v21 row_shr:8 row_mask:0xf bank_mask:0xf bound_ctrl:0
    s_nop 1
    s_nop 1
    v_readlane_b32 s10, v20, 15
    v_readlane_b32 s11, v20, 31
    v_readlane_b32 s49, v20, 47
    v_readlane_b32 s50, v20, 63
    v_readlane_b32 s51, v21, 15
    v_readlane_b32 s52, v21, 31
    v_readlane_b32 s53, v21, 47
    v_readlane_b32 s54, v21, 63
    s_nop 3
    v_mov_b32 v22, s10
    v_mov_b32 v23, s51
    v_add_f32 v22, s11, v22
    v_add_f32 v23, s52, v23
    v_add_f32 v22, s49, v22
    v_add_f32 v23, s53, v23
    v_add_f32 v22, s50, v22
    v_add_f32 v23, s54, v23
    v_cmp_eq_u32 vcc, 1, v1
    s_nop 1
    v_cndmask_b32 v22, v22, v23, vcc
    v_mul_f32 v22, 0xbfb8aa3b, v22
    v_exp_f32 v22, v22
    s_nop 0
    v_add_f32 v22, 1.0, v22
    v_rcp_f32 v22, v22
    s_lshl_b32 s10, s35, 2
    s_add_u32 s10, s10, 0x1200000
    v_lshlrev_b32 v23, 2, v1
    s_mov_b64 exec, 3
    buffer_store_dword v22, v23, s[12:15], s10 offen sc1
    s_mov_b64 exec, -1
    s_waitcnt vmcnt(0)
    s_barrier
    s_cmp_lg_u32 s26, 8
    s_cbranch_scc1 P2H_NOF3
    s_lshl_b32 s58, s2, 6
    s_add_u32 s58, s58, 0x1218000
    v_mov_b32 v12, s58
    v_mov_b32 v14, s56
    v_mov_b32 v15, s57
    s_mov_b64 exec, 1
    buffer_store_dwordx2 v[14:15], v12, s[12:15], 0 offen sc0 sc1
    s_mov_b64 exec, -1
P2H_NOF3:
    s_add_u32 s44, s34, 4
P2H_WO:
    s_mul_i32 s43, s41, 24576
    s_add_u32 s43, s43, s27
    s_add_u32 m0, s42, s40
    s_add_u32 s41, s41, 1
    buffer_load_dwordx4 v10, s[12:15], s43 offen sc1 lds
    buffer_load_dwordx4 v10, s[12:15], s43 offen offset:1024 sc1 lds
    buffer_load_dwordx4 v10, s[12:15], s43 offen offset:2048 sc1 lds
    buffer_load_dwordx4 v10, s[12:15], s43 offen offset:3072 sc1 lds
    s_add_u32 m0, m0, 4096
    s_add_u32 s43, s43, 4096
    s_and_b32 s41, s41, 7
    buffer_load_dwordx4 v10, s[12:15], s43 offen sc1 lds
    buffer_load_dwordx4 v10, s[12:15], s43 offen offset:1024 sc1 lds
    s_add_u32 s42, s42, 24576
    s_cmp_ge_u32 s42, 73728
    s_cselect_b32 s42, 0, s42
    s_mul_i32 s10, s44, 40960
    s_mul_i32 s11, s44, 5120
    s_add_u32 s11, s11, 61184
    s_add_u32 m0, s11, 0
    s_nop 0
    buffer_load_dwordx4 v24, s[36:39], s10 offen lds
    s_add_u32 m0, s11, 1024
    s_nop 0
    buffer_load_dwordx4 v25, s[36:39], s10 offen lds
    s_add_u32 m0, s11, 2048
    s_nop 0
    buffer_load_dwordx4 v26, s[36:39], s10 offen lds
    s_add_u32 m0, s11, 3072
    s_nop 0
    buffer_load_dwordx4 v27, s[36:39], s10 offen lds
    s_add_u32 m0, s11, 4096
    s_nop 0
    buffer_load_dwordx4 v28, s[36:39], s10 offen lds
    s_waitcnt vmcnt(5)
    s_barrier
    s_add_u32 s44, s44, 4
    s_cmp_lt_u32 s44, 20
    s_cbranch_scc1 P2H_WO
    s_mul_i32 s43, s41, 24576
    s_add_u32 s43, s43, s27
    s_add_u32 m0, s42, s40
    s_add_u32 s41, s41, 1
    buffer_load_dwordx4 v10, s[12:15], s43 offen sc1 lds
    buffer_load_dwordx4 v10, s[12:15], s43 offen offset:1024 sc1 lds
    buffer_load_dwordx4 v10, s[12:15], s43 offen offset:2048 sc1 lds
    buffer_load_dwordx4 v10, s[12:15], s43 offen offset:3072 sc1 lds
    s_add_u32 m0, m0, 4096
    s_add_u32 s43, s43, 4096
    s_and_b32 s41, s41, 7
    buffer_load_dwordx4 v10, s[12:15], s43 offen sc1 lds
    buffer_load_dwordx4 v10, s[12:15], s43 offen offset:1024 sc1 lds
    s_add_u32 s42, s42, 24576
    s_cmp_ge_u32 s42, 73728
    s_cselect_b32 s42, 0, s42
    v_lshlrev_b32 v5, 6, v1
    v_add_u32 v5, 0x1218000, v5
    v_add_u32 v6, 4096, v5
    v_add_u32 v7, 8192, v5
    v_add_u32 v8, 12288, v5
    s_waitcnt vmcnt(0)
    s_barrier
    s_mul_i32 s43, s41, 24576
    s_add_u32 s43, s43, s27
    s_add_u32 m0, s42, s40
    s_add_u32 s41, s41, 1
    buffer_load_dwordx4 v10, s[12:15], s43 offen sc1 lds
    buffer_load_dwordx4 v10, s[12:15], s43 offen offset:1024 sc1 lds
    buffer_load_dwordx4 v10, s[12:15], s43 offen offset:2048 sc1 lds
    buffer_load_dwordx4 v10, s[12:15], s43 offen offset:3072 sc1 lds
    s_add_u32 m0, m0, 4096
    s_add_u32 s43, s43, 4096
    s_and_b32 s41, s41, 7
    buffer_load_dwordx4 v10, s[12:15], s43 offen sc1 lds
    buffer_load_dwordx4 v10, s[12:15], s43 offen offset:1024 sc1 lds
    s_add_u32 s42, s42, 24576
    s_cmp_ge_u32 s42, 73728
    s_cselect_b32 s42, 0, s42
    s_cmp_lg_u32 s26, 8
    s_cbranch_scc1 P2H_NOP3
    s_mov_b32 s10, 0
POLL_47:
    buffer_load_dwordx2 v[12:13], v5, s[12:15], 0 offen sc0 sc1
    buffer_load_dwordx2 v[14:15], v6, s[12:15], 0 offen sc0 sc1
    buffer_load_dwordx2 v[16:17], v7, s[12:15], 0 offen sc0 sc1
    buffer_load_dwordx2 v[18:19], v8, s[12:15], 0 offen sc0 sc1
POLLC_49:
    s_waitcnt vmcnt(0)
    v_cmp_ne_u64 vcc, s[56:57], v[12:13]
    v_cmp_ne_u64 s[58:59], s[56:57], v[14:15]
    s_or_b64 vcc, vcc, s[58:59]
    v_cmp_ne_u64 s[58:59], s[56:57], v[16:17]
    s_or_b64 vcc, vcc, s[58:59]
    v_cmp_ne_u64 s[58:59], s[56:57], v[18:19]
    s_or_b64 vcc, vcc, s[58:59]
    s_add_u32 s10, s10, 1
    s_cmp_gt_u32 s10, 30000
    s_cbranch_scc1 POLLD_48
    s_cmp_lg_u64 vcc, 0
    s_cbranch_scc1 POLL_47
POLLD_48:
P2H_NOP3:
    s_waitcnt vmcnt(0)
    s_barrier
    s_mul_i32 s10, s34, 40960
    s_mul_i32 s11, s34, 5120
    s_add_u32 s11, s11, 61184
    s_add_u32 m0, s11, 0
    s_nop 0
    buffer_load_dwordx4 v24, s[36:39], s10 offen lds
    s_add_u32 m0, s11, 1024
    s_nop 0
    buffer_load_dwordx4 v25, s[36:39], s10 offen lds
    s_add_u32 m0, s11, 2048
    s_nop 0
    buffer_load_dwordx4 v26, s[36:39], s10 offen lds
    s_add_u32 m0, s11, 3072
    s_nop 0
    buffer_load_dwordx4 v27, s[36:39], s10 offen lds
    s_add_u32 m0, s11, 4096
    s_nop 0
    buffer_load_dwordx4 v28, s[36:39], s10 offen lds
    s_lshl_b32 s10, s24, 6
    s_lshl_b32 s11, s34, 4
    s_add_u32 s10, s10, s11
    s_mul_i32 s10, s10, 1280
    s_mul_i32 s11, s34, 2560
    s_add_u32 s11, s11, 49152
    s_add_u32 m0, s11, 0
    s_nop 0
    buffer_load_dwordx4 v24, s[16:19], s10 offen lds
    s_add_u32 m0, s11, 1024
    s_nop 0
    buffer_load_dwordx4 v25, s[16:19], s10 offen lds
    s_add_u32 m0, s11, 2048
    s_mov_b32 exec_hi, 0
    buffer_load_dwordx4 v26, s[16:19], s10 offen lds
    s_mov_b64 exec, -1
    v_lshrrev_b32 v7, 3, v1
    v_lshlrev_b32 v7, 12, v7
    v_and_b32 v8, 7, v1
    v_lshl_add_u32 v7, v8, 4, v7
    s_mul_i32 s10, s25, 80
    s_lshl_b32 s10, s10, 12
    s_lshl_b32 s11, s24, 7
    s_add_u32 s10, s10, s11
    s_add_u32 s10, s10, 0xc00000
    s_lshl_b32 s11, s34, 15
    s_add_u32 s10, s10, s11
    s_lshl_b32 s11, s34, 10
    s_add_u32 s11, s11, 0
    s_barrier
    s_add_u32 s43, s10, 0
    s_add_u32 m0, s11, 0
    s_nop 0
    buffer_load_dwordx4 v7, s[12:15], s43 offen sc1 lds
    s_add_u32 s43, s10, 131072
    s_add_u32 m0, s11, 4096
    s_nop 0
    buffer_load_dwordx4 v7, s[12:15], s43 offen sc1 lds
    s_cmp_lt_u32 s34, 2
    s_cselect_b32 s44, 2, 1
    s_lshl_b32 s43, s44, 17
    s_lshl_b32 s44, s44, 12
    s_add_u32 s43, s43, s10
    s_add_u32 m0, s11, s44
    s_nop 0
    buffer_load_dwordx4 v7, s[12:15], s43 offen sc1 lds
    v_mov_b32 v5, 163648
    v_mov_b32 v6, 1
    s_waitcnt vmcnt(0)
    s_mov_b64 exec, 1
    ds_add_u32 v5, v6
    s_mov_b64 exec, -1
    s_cmp_lg_u32 s26, 8
    s_cbranch_scc1 P2H_FIN
    s_lshr_b32 s10, s24, 2
    s_lshl_b32 s10, s10, 3
    s_and_b32 s11, s24, 3
    s_lshl_b32 s11, s11, 1
    s_add_u32 s10, s10, s11
    v_lshlrev_b32 v7, 6, v2
    v_add3_u32 v7, v7, v3, s10
    v_lshlrev_b32 v7, 6, v7
    v_add_u32 v7, 0x1220000, v7
    v_mov_b32 v8, 163672
    s_mov_b32 s10, 0
    s_mov_b64 s[20:21], 0
P2H_OP:
    s_not_b64 exec, s[20:21]
    buffer_load_dwordx2 v[12:13], v7, s[12:15], 0 offen sc0 sc1
    s_waitcnt vmcnt(0)
    v_cmp_eq_u64 vcc, s[56:57], v[12:13]
    s_mov_b64 exec, -1
    s_or_b64 s[20:21], s[20:21], vcc
    s_add_u32 s10, s10, 1
    v_mov_b32 v14, s20
    v_mov_b32 v15, s21
    ds_write_b64 v8, v[14:15]
    s_cmp_gt_u32 s10, 30000
    s_cbranch_scc1 P2H_FIN
    s_cmp_lg_u64 s[20:21], -1
    s_cbranch_scc1 P2H_OP
P2H_FIN:
    s_waitcnt lgkmcnt(0)
L_END:
    s_endpgm
.section .rodata,"a"
.p2align 6
.amdhsa_kernel gated_mix__softmax_full_mha__ssm_conv_h3__prompt_kernel
  .amdhsa_next_free_vgpr 168
  .amdhsa_next_free_sgpr 102
  .amdhsa_accum_offset 168
  .amdhsa_group_segment_fixed_size 0
  .amdhsa_kernarg_size 104
  .amdhsa_user_sgpr_count 2
  .amdhsa_user_sgpr_kernarg_segment_ptr 1
  .amdhsa_system_sgpr_workgroup_id_x 1
.end_amdhsa_kernel
```
